```python
import torch

def _softmax(x, axis=-1):
    return torch.softmax(x, dim=axis)
def _gelu(x):
    return torch.nn.functional.gelu(x, approximate="tanh")
def _silu(x):
    return torch.nn.functional.silu(x)
def _sigmoid(x):
    return torch.sigmoid(x)
def _layernorm(x, axis=-1, eps=1e-5):
    m = x.mean(dim=axis, keepdim=True)
    v = x.var(dim=axis, keepdim=True, unbiased=False)
    return (x - m) / torch.sqrt(v + eps)
def _scatter_add(tgt, idx, src, axis=0):
    return tgt.clone().index_add_(axis, idx, src)
def _segment_sum(src, seg, n):
    out = torch.zeros((n,) + src.shape[1:], dtype=src.dtype)
    return out.index_add_(0, seg, src)
def _pad(x, pw):
    flat = tuple(v for pair in reversed(pw) for v in pair)
    return torch.nn.functional.pad(x, flat)

kernel_name = 'sequential_preLN__compressed_kv_cla__glu_gated_reglu__decode'

def setup_inputs():

    _w = (lambda a: (lambda t: t.to(torch.bfloat16) if t.is_floating_point() else t)(torch.as_tensor(a)))
    def _A_setup():
        B, H, Sq, Sk, D, M = 4, 32, 1, 4096, 128, 512
        Dc = 4 * D
        return {
            "x": _w((lambda *s: torch.randn(*s, dtype=torch.bfloat16) * 0.05)(B, Sq, M)),
            "c_kv": _w((lambda *s: torch.randn(*s, dtype=torch.bfloat16) * 0.8)(B, Sk, Dc)),
            "w_q": _w((lambda *s: torch.randn(*s, dtype=torch.bfloat16) * 1.6)(M, H, D) * (M ** -0.5)),
            "w_uk": _w((lambda *s: torch.randn(*s, dtype=torch.bfloat16) * 1.6)(Dc, H, D) * (Dc ** -0.5)),
            "w_uv": _w((lambda *s: torch.randn(*s, dtype=torch.bfloat16) * 0.8)(Dc, H, D) * (Dc ** -0.5)),
            "w_o": _w((lambda *s: torch.randn(*s, dtype=torch.bfloat16) * 0.8)(H, D, M) * ((H * D) ** -0.5)),
        }
    _A_in = _A_setup()

    def _B_setup():
        B, S, D, F = 4, 1, 512, 1376
        return {
            "x": _w((lambda *s: torch.randn(*s, dtype=torch.bfloat16) * 0.05)(B, S, D)),
            "W_gate": _w((lambda *s: torch.randn(*s, dtype=torch.bfloat16) * 0.4)(D, F) * (2.0 / D) ** 0.5),
            "W_up": _w((lambda *s: torch.randn(*s, dtype=torch.bfloat16) * 0.4)(D, F) * (2.0 / D) ** 0.5),
            "W_down": _w((lambda *s: torch.randn(*s, dtype=torch.bfloat16) * 0.4)(F, D) * (1.0 / F) ** 0.5),
        }
    _B_in = _B_setup()

    return {
        "A_x": _A_in["x"],
        "A_c_kv": _A_in["c_kv"],
        "A_w_q": _A_in["w_q"],
        "A_w_uk": _A_in["w_uk"],
        "A_w_uv": _A_in["w_uv"],
        "A_w_o": _A_in["w_o"],
        "B_x": _B_in["x"],
        "B_W_gate": _B_in["W_gate"],
        "B_W_up": _B_in["W_up"],
        "B_W_down": _B_in["W_down"],
    }

def reference(A_x, A_c_kv, A_w_q, A_w_uk, A_w_uv, A_w_o, B_x, B_W_gate, B_W_up, B_W_down):
    def _A_ref(x, c_kv, w_q, w_uk, w_uv, w_o):
        B, Sq, M = x.shape[0], x.shape[1], x.shape[2]
        Sk = c_kv.shape[1]
        H, D = w_q.shape[1], w_q.shape[2]
        q = torch.einsum("bqm,mhd->bhqd", x, w_q)
        k = torch.einsum("bkc,chd->bhkd", c_kv, w_uk)
        v = torch.einsum("bkc,chd->bhkd", c_kv, w_uv)
        scores = torch.einsum("bhqd,bhkd->bhqk", q, k) * (D ** -0.5)
        off = Sk - Sq
        qi = torch.arange(Sq)[:, None]
        kj = torch.arange(Sk)[None, :]
        cmask = kj <= (qi + off)
        scores = torch.where(cmask[None, None], scores, -1e9)
        p = _softmax(scores, axis=-1)
        ctx = torch.einsum("bhqk,bhkd->bhqd", p, v)
        return torch.einsum("bhqd,hdm->bqm", ctx, w_o)

    def _B_ref(x, W_gate, W_up, W_down):
        gate = torch.einsum("bsd,df->bsf", x, W_gate)
        up = torch.einsum("bsd,df->bsf", x, W_up)
        gate = gate * (lambda x, dt: x.to(dt))(gate > 0, gate.dtype)
        h = gate * up
        return torch.einsum("bsf,fd->bsd", h, W_down)

    x = A_x
    h = x + _A_ref(_layernorm(x, axis=-1), A_c_kv, A_w_q, A_w_uk, A_w_uv, A_w_o)
    h2 = h + _B_ref(_layernorm(h, axis=-1), B_W_gate, B_W_up, B_W_down)
    return h2
```

```asm
; @launch grid=(256,1,1) block=(512,1,1) lds=163840
.amdgcn_target "amdgcn-amd-amdhsa--gfx950"
.text
.globl sequential_preLN__compressed_kv_cla__glu_gated_reglu__decode_kernel
.p2align 8
.type sequential_preLN__compressed_kv_cla__glu_gated_reglu__decode_kernel,@function
sequential_preLN__compressed_kv_cla__glu_gated_reglu__decode_kernel:
    s_cmp_ge_u32 s2, 256
    s_cbranch_scc1 END
    s_load_dwordx2 s[4:5], s[0:1], 0
    s_load_dwordx2 s[12:13], s[0:1], 16
    s_load_dwordx2 s[8:9], s[0:1], 8
    s_load_dwordx2 s[44:45], s[0:1], 96
    v_readfirstlane_b32 s48, v0
    v_and_b32 v1, 63, v0
    v_and_b32 v2, 15, v0
    s_lshr_b32 s48, s48, 6
    v_lshrrev_b32 v3, 4, v1
    s_and_b32 s64, s2, 7
    s_lshr_b32 s65, s2, 3
    s_cmp_ge_u32 s48, 4
    s_cbranch_scc1 LOADER
    s_and_b32 s55, s65, 3
    s_lshl_b32 s55, s55, 3
    s_add_u32 s55, s55, s64
    s_lshr_b32 s56, s65, 2
    s_mov_b32 s6, 0x1000
    s_mov_b32 s7, 0x20000
    s_mov_b32 s14, 0x400000
    s_mov_b32 s15, 0x20000
    v_lshlrev_b32 v8, 4, v0
    v_lshrrev_b32 v9, 3, v1
    v_lshlrev_b32 v9, 13, v9
    v_bfe_u32 v10, v1, 1, 2
    v_xor_b32 v10, v10, v3
    v_lshl_add_u32 v9, v10, 5, v9
    v_and_b32 v10, 1, v1
    v_lshl_add_u32 v9, v10, 4, v9
    s_lshr_b32 s64, s56, 1
    s_lshl_b32 s64, s64, 20
    s_lshl_b32 s65, s48, 18
    s_add_u32 s64, s64, s65
    s_lshl_b32 s65, s55, 8
    s_add_u32 s64, s64, s65
    s_and_b32 s65, s56, 1
    s_lshl_b32 s65, s65, 7
    s_add_u32 s64, s64, s65
    s_lshl_b32 s66, s48, 12
    s_add_u32 s66, s66, 135168
    v_mov_b32 v12, 161056
    v_mov_b32 v20, 0
    v_mov_b32 v21, 0
    v_mov_b32 v22, 0
    v_mov_b32 v23, 0
    ds_write_b128 v12, v[20:23]
    ds_write_b32 v12, v20 offset:16
    s_waitcnt lgkmcnt(0)
    buffer_load_dwordx4 v[16:19], v8, s[4:7], 0 offen
    s_mov_b32 m0, s66
    s_add_u32 s66, s66, 1024
    buffer_load_dwordx4 v9, s[12:15], s64 offen nt lds
    s_add_u32 s64, s64, 65536
    s_mov_b32 m0, s66
    s_add_u32 s66, s66, 1024
    buffer_load_dwordx4 v9, s[12:15], s64 offen nt lds
    s_add_u32 s64, s64, 65536
    s_mov_b32 m0, s66
    s_add_u32 s66, s66, 1024
    buffer_load_dwordx4 v9, s[12:15], s64 offen nt lds
    s_add_u32 s64, s64, 65536
    s_mov_b32 m0, s66
    s_add_u32 s66, s66, 1024
    buffer_load_dwordx4 v9, s[12:15], s64 offen nt lds
    s_load_dword s49, s[44:45], 0
    s_barrier
    s_and_b32 s64, s2, 7
    s_lshr_b32 s65, s2, 3
    s_lshr_b32 s60, s65, 1
    s_lshl_b32 s60, s60, 3
    s_add_u32 s60, s60, s64
    s_and_b32 s58, s65, 1
    s_lshr_b32 s57, s60, 5
    s_and_b32 s59, s60, 31
    s_load_dwordx2 s[16:17], s[0:1], 24
    s_load_dwordx2 s[20:21], s[0:1], 32
    s_load_dwordx2 s[24:25], s[0:1], 40
    s_load_dwordx2 s[28:29], s[0:1], 56
    s_load_dwordx2 s[32:33], s[0:1], 64
    s_load_dwordx2 s[36:37], s[0:1], 72
    s_load_dwordx2 s[40:41], s[0:1], 80
    s_sub_u32 s61, s65, 16
    s_mov_b32 s62, s64
    s_mul_i32 s63, s64, 6
    s_add_u32 s63, s63, s65
    s_sub_u32 s63, s63, 24
    s_mov_b32 s79, 3
    s_cmp_lt_u32 s63, 43
    s_cselect_b32 s79, 2, s79
    s_cmp_ge_u32 s65, 30
    s_cselect_b32 s79, 3, s79
    s_cmp_lt_u32 s65, 24
    s_cselect_b32 s79, 1, s79
    s_cmp_lt_u32 s65, 16
    s_cselect_b32 s79, 0, s79
    s_mov_b32 s10, 0x1000000
    s_mov_b32 s11, 0x20000
    s_mov_b32 s46, 0x10000000
    s_mov_b32 s47, 0x20000
    s_mov_b32 s18, 0x400000
    s_mov_b32 s19, 0x20000
    s_mov_b32 s22, 0x400000
    s_mov_b32 s23, 0x20000
    s_mov_b32 s26, 0x400000
    s_mov_b32 s27, 0x20000
    s_mov_b32 s30, 0x158000
    s_mov_b32 s31, 0x20000
    s_mov_b32 s34, 0x158000
    s_mov_b32 s35, 0x20000
    s_mov_b32 s38, 0x158000
    s_mov_b32 s39, 0x20000
    s_mov_b32 s42, 0x1000
    s_mov_b32 s43, 0x20000
    s_mov_b32 s78, 0
    v_mov_b32 v7, 0x10001
    v_mov_b32 v14, 0
    v_mov_b32 v15, 0
    v_mov_b32 v96, 0
    v_mov_b32 v97, 0
    v_mov_b32 v98, 0
    v_mov_b32 v99, 0
    v_mov_b32 v100, 0
    v_mov_b32 v101, 0
    v_mov_b32 v102, 0
    v_mov_b32 v103, 0
    v_mov_b32 v104, 0
    v_mov_b32 v105, 0
    v_mov_b32 v106, 0
    v_mov_b32 v107, 0
    v_mov_b32 v108, 0
    v_mov_b32 v109, 0
    v_mov_b32 v110, 0
    v_mov_b32 v111, 0
    v_mov_b32 v112, 0
    v_mov_b32 v113, 0
    v_mov_b32 v114, 0
    v_mov_b32 v115, 0
    v_mov_b32 v116, 0
    v_mov_b32 v117, 0
    v_mov_b32 v118, 0
    v_mov_b32 v119, 0
    v_mov_b32 v120, 0
    v_mov_b32 v121, 0
    v_mov_b32 v122, 0
    v_mov_b32 v123, 0
    v_lshrrev_b32 v10, 2, v1
    v_lshlrev_b32 v10, 6, v10
    v_and_b32 v11, 1, v1
    v_lshl_add_u32 v10, v11, 5, v10
    v_bfe_u32 v11, v1, 1, 1
    v_lshl_add_u32 v10, v11, 3, v10
    s_mul_i32 s65, s48, 1088
    s_add_u32 s65, s65, 151552
    v_add_u32 v10, s65, v10
    v_bfe_u32 v11, v2, 2, 2
    v_lshl_add_u32 v11, v3, 2, v11
    v_bfe_u32 v13, v11, 1, 2
    v_xor_b32 v13, s48, v13
    v_lshlrev_b32 v13, 5, v13
    v_lshl_add_u32 v8, v11, 7, v13
    v_and_b32 v13, 3, v1
    v_lshl_add_u32 v8, v13, 3, v8
    v_add_u32 v8, 135168, v8
    v_and_b32 v9, 3, v2
    v_mul_u32_u24 v9, 1088, v9
    v_lshl_add_u32 v9, v3, 4, v9
    s_lshr_b32 s65, s56, 1
    s_lshl_b32 s65, s65, 8
    s_add_u32 s65, s65, 151552
    v_add_u32 v9, s65, v9
    v_lshlrev_b32 v14, 5, v2
    v_lshl_add_u32 v14, v3, 3, v14
    s_lshl_b32 s69, s55, 3
    s_and_b32 s65, s56, 1
    s_lshl_b32 s65, s65, 2
    s_add_u32 s69, s69, s65
    s_lshr_b32 s65, s56, 1
    s_add_u32 s69, s69, s65
    s_lshl_b32 s69, s69, 2
    s_add_u32 s69, s69, s48
    s_lshl_b32 s69, s69, 7
    s_add_u32 s69, s69, 65536
    v_mov_b32 v15, 0x3e0293ee
    s_waitcnt vmcnt(4)
    v_lshlrev_b32 v20, 16, v16
    v_and_b32 v21, 0xffff0000, v16
    v_lshlrev_b32 v22, 16, v17
    v_and_b32 v23, 0xffff0000, v17
    v_lshlrev_b32 v24, 16, v18
    v_and_b32 v25, 0xffff0000, v18
    v_lshlrev_b32 v26, 16, v19
    v_and_b32 v27, 0xffff0000, v19
    v_add_f32 v28, v20, v21
    v_mul_f32 v29, v20, v20
    v_fmac_f32 v29, v21, v21
    v_add_f32 v28, v28, v22
    v_fmac_f32 v29, v22, v22
    v_add_f32 v28, v28, v23
    v_fmac_f32 v29, v23, v23
    v_add_f32 v28, v28, v24
    v_fmac_f32 v29, v24, v24
    v_add_f32 v28, v28, v25
    v_fmac_f32 v29, v25, v25
    v_add_f32 v28, v28, v26
    v_fmac_f32 v29, v26, v26
    v_add_f32 v28, v28, v27
    v_fmac_f32 v29, v27, v27
    s_nop 0
    v_add_f32_dpp v28, v28, v28 row_ror:1 row_mask:0xf bank_mask:0xf
    v_add_f32_dpp v29, v29, v29 row_ror:1 row_mask:0xf bank_mask:0xf
    s_nop 0
    v_add_f32_dpp v28, v28, v28 row_ror:2 row_mask:0xf bank_mask:0xf
    v_add_f32_dpp v29, v29, v29 row_ror:2 row_mask:0xf bank_mask:0xf
    s_nop 0
    v_add_f32_dpp v28, v28, v28 row_ror:4 row_mask:0xf bank_mask:0xf
    v_add_f32_dpp v29, v29, v29 row_ror:4 row_mask:0xf bank_mask:0xf
    s_nop 0
    v_add_f32_dpp v28, v28, v28 row_ror:8 row_mask:0xf bank_mask:0xf
    v_add_f32_dpp v29, v29, v29 row_ror:8 row_mask:0xf bank_mask:0xf
    v_mov_b32 v30, v28
    v_mov_b32 v31, v29
    s_nop 0
    v_permlane16_swap_b32 v30, v28
    v_permlane16_swap_b32 v31, v29
    v_add_f32 v28, v28, v30
    v_add_f32 v29, v29, v31
    v_mov_b32 v30, v28
    v_mov_b32 v31, v29
    s_nop 0
    v_permlane32_swap_b32 v30, v28
    v_permlane32_swap_b32 v31, v29
    v_add_f32 v28, v28, v30
    v_add_f32 v29, v29, v31
    v_mul_f32 v28, 0x3b000000, v28
    v_mul_f32 v29, 0x3b000000, v29
    v_fma_f32 v29, -v28, v28, v29
    v_add_f32 v29, 0x3727c5ac, v29
    v_rsq_f32 v29, v29
    s_nop 0
    v_mul_f32 v28, v28, v29
    v_fma_f32 v20, v20, v29, -v28
    v_fma_f32 v21, v21, v29, -v28
    v_fma_f32 v22, v22, v29, -v28
    v_fma_f32 v23, v23, v29, -v28
    v_fma_f32 v24, v24, v29, -v28
    v_fma_f32 v25, v25, v29, -v28
    v_fma_f32 v26, v26, v29, -v28
    v_fma_f32 v27, v27, v29, -v28
    v_cvt_pk_bf16_f32 v16, v20, v21
    v_cvt_pk_bf16_f32 v17, v22, v23
    v_cvt_pk_bf16_f32 v18, v24, v25
    v_cvt_pk_bf16_f32 v19, v26, v27
    ds_write_b64 v10, v[16:17]
    ds_write_b64 v10, v[18:19] offset:16
    s_waitcnt lgkmcnt(0)
    v_mov_b32 v32, v8
    v_mov_b32 v33, v9
    v_mov_b32 v34, v14
    s_and_b32 s50, s49, 1
    s_bfe_u32 s64, s49, 0x10001
    s_lshl_b32 s64, s64, 16
    s_or_b32 s50, s50, s64
    s_bfe_u32 s51, s49, 0x10002
    s_bfe_u32 s64, s49, 0x10003
    s_lshl_b32 s64, s64, 16
    s_or_b32 s51, s51, s64
    s_xor_b32 s52, s50, 0x10001
    s_xor_b32 s53, s51, 0x10001
    s_mul_i32 s54, s49, 0x9e3779b1
    s_add_u32 s54, s54, 0x7f4a7c15
    v_and_b32 v8, 1, v3
    v_cmp_ne_u32 vcc, 0, v8
    v_mov_b32 v9, s50
    v_mov_b32 v10, s52
    v_cndmask_b32 v5, v9, v10, vcc
    v_mov_b32 v11, s51
    v_mov_b32 v12, s53
    v_cndmask_b32 v6, v11, v12, vcc
    v_and_b32 v8, 2, v1
    v_cmp_ne_u32 vcc, 0, v8
    s_nop 1
    v_cndmask_b32 v13, v9, v11, vcc
    v_cndmask_b32 v14, v10, v12, vcc
    v_and_b32 v8, 4, v1
    v_cmp_ne_u32 vcc, 0, v8
    s_nop 1
    v_cndmask_b32 v13, v13, v14, vcc
    v_and_b32 v8, 1, v1
    v_lshlrev_b32 v8, 4, v8
    v_lshrrev_b32 v13, v8, v13
    v_and_b32 v13, 1, v13
    v_mul_u32_u24 v4, v7, v13
    s_lshl_b32 s65, s48, 2
    s_add_u32 s65, s65, 161056
    v_mov_b32 v12, s65
    v_mov_b32 v13, 1
    v_mov_b32 v11, 161056
    s_waitcnt vmcnt(0)
    ds_write_b32 v12, v13
A_RDY:
    ds_read_b128 v[16:19], v11
    s_add_u32 s78, s78, 1
    s_cmp_gt_u32 s78, 0x200000
    s_cbranch_scc1 FAIL
    s_waitcnt lgkmcnt(0)
    v_and_b32 v16, v16, v17
    v_and_b32 v18, v18, v19
    v_and_b32 v16, v16, v18
    v_cmp_eq_u32 vcc, 0, v16
    s_nop 0
    s_cbranch_vccnz A_RDY
    ds_read_b64_tr_b16 v[64:65], v32 offset:0
    ds_read_b64_tr_b16 v[66:67], v32 offset:2048
    ds_read_b128 v[80:83], v33 offset:0
    ds_read_b64_tr_b16 v[68:69], v32 offset:4096
    ds_read_b64_tr_b16 v[70:71], v32 offset:6144
    ds_read_b128 v[84:87], v33 offset:64
    ds_read_b64_tr_b16 v[72:73], v32 offset:8192
    ds_read_b64_tr_b16 v[74:75], v32 offset:10240
    ds_read_b128 v[88:91], v33 offset:128
    ds_read_b64_tr_b16 v[76:77], v32 offset:12288
    ds_read_b64_tr_b16 v[78:79], v32 offset:14336
    ds_read_b128 v[92:95], v33 offset:192
    s_waitcnt lgkmcnt(9)
    v_mfma_f32_16x16x32_bf16 v[16:19], v[64:67], v[80:83], 0
    s_waitcnt lgkmcnt(6)
    v_mfma_f32_16x16x32_bf16 v[16:19], v[68:71], v[84:87], v[16:19]
    s_waitcnt lgkmcnt(3)
    v_mfma_f32_16x16x32_bf16 v[16:19], v[72:75], v[88:91], v[16:19]
    s_waitcnt lgkmcnt(0)
    v_mfma_f32_16x16x32_bf16 v[16:19], v[76:79], v[92:95], v[16:19]
    s_mov_b32 exec_lo, 0x000f000f
    s_mov_b32 exec_hi, 0x000f000f
    s_nop 5
    v_mul_f32 v16, v16, v15
    v_mul_f32 v17, v17, v15
    v_mul_f32 v18, v18, v15
    v_mul_f32 v19, v19, v15
    v_cvt_pk_bf16_f32 v20, v16, v17
    v_cvt_pk_bf16_f32 v21, v18, v19
    v_bfi_b32 v20, v7, v5, v20
    v_bfi_b32 v21, v7, v6, v21
    buffer_store_dwordx2 v[20:21], v34, s[44:47], s69 offen sc1
    s_mov_b64 exec, -1
    s_cmp_lg_u32 s48, 0
    s_cbranch_scc1 A_HELP
    v_lshrrev_b32 v11, 2, v2
    v_lshlrev_b32 v11, 3, v11
    v_and_b32 v12, 3, v2
    v_add_u32 v11, v11, v12
    v_lshlrev_b32 v11, 13, v11
    v_lshl_add_u32 v11, v3, 4, v11
    s_lshl_b32 s66, s56, 19
    s_lshl_b32 s65, s55, 8
    s_add_u32 s66, s66, s65
    s_add_u32 s65, s66, 0
    buffer_load_dwordx4 a[0:3], v11, s[16:19], s65 offen offset:0 nt
    buffer_load_dwordx4 a[4:7], v11, s[16:19], s65 offen offset:64 nt
    buffer_load_dwordx4 a[8:11], v11, s[16:19], s65 offen offset:128 nt
    buffer_load_dwordx4 a[12:15], v11, s[16:19], s65 offen offset:192 nt
    s_add_u32 s65, s66, 32768
    buffer_load_dwordx4 a[16:19], v11, s[16:19], s65 offen offset:0 nt
    buffer_load_dwordx4 a[20:23], v11, s[16:19], s65 offen offset:64 nt
    buffer_load_dwordx4 a[24:27], v11, s[16:19], s65 offen offset:128 nt
    buffer_load_dwordx4 a[28:31], v11, s[16:19], s65 offen offset:192 nt
    s_add_u32 s65, s66, 262144
    buffer_load_dwordx4 a[32:35], v11, s[16:19], s65 offen offset:0 nt
    buffer_load_dwordx4 a[36:39], v11, s[16:19], s65 offen offset:64 nt
    buffer_load_dwordx4 a[40:43], v11, s[16:19], s65 offen offset:128 nt
    buffer_load_dwordx4 a[44:47], v11, s[16:19], s65 offen offset:192 nt
    s_add_u32 s65, s66, 294912
    buffer_load_dwordx4 a[48:51], v11, s[16:19], s65 offen offset:0 nt
    buffer_load_dwordx4 a[52:55], v11, s[16:19], s65 offen offset:64 nt
    buffer_load_dwordx4 a[56:59], v11, s[16:19], s65 offen offset:128 nt
    buffer_load_dwordx4 a[60:63], v11, s[16:19], s65 offen offset:192 nt
    v_lshrrev_b32 v10, 2, v2
    v_lshlrev_b32 v10, 9, v10
    v_lshrrev_b32 v11, 1, v3
    v_lshl_add_u32 v10, v11, 7, v10
    v_and_b32 v11, 3, v2
    v_lshl_add_u32 v10, v11, 5, v10
    v_and_b32 v11, 1, v3
    v_lshl_add_u32 v10, v11, 4, v10
    s_lshl_b32 s64, s55, 12
    s_add_u32 s64, s64, 65536
    v_and_b32 v9, 3, v2
    v_lshlrev_b32 v9, 15, v9
    v_bfe_u32 v11, v2, 2, 1
    v_lshl_add_u32 v9, v11, 6, v9
    v_lshl_add_u32 v9, v3, 4, v9
    s_lshl_b32 s66, s55, 3
    s_add_u32 s66, s66, s56
    s_lshl_b32 s66, s66, 7
    s_add_u32 s66, s66, 7340032
    v_mov_b32 v13, 1
    v_mov_b32 v8, 161072
    s_waitcnt vmcnt(16)
H1_RETRY:
    buffer_load_dwordx4 v[64:67], v10, s[44:47], s64 offen offset:0 sc1
    buffer_load_dwordx4 v[68:71], v10, s[44:47], s64 offen offset:256 sc1
    buffer_load_dwordx4 v[72:75], v10, s[44:47], s64 offen offset:2048 sc1
    buffer_load_dwordx4 v[76:79], v10, s[44:47], s64 offen offset:2304 sc1
    s_add_u32 s78, s78, 1
    s_cmp_gt_u32 s78, 0x200000
    s_cbranch_scc1 FAIL
    v_mov_b32 v12, 0
    s_waitcnt vmcnt(0)
    v_bitop3_b32 v12, v12, v64, s50 bitop3:0xf6
    v_bitop3_b32 v12, v12, v65, s51 bitop3:0xf6
    v_bitop3_b32 v12, v12, v66, s52 bitop3:0xf6
    v_bitop3_b32 v12, v12, v67, s53 bitop3:0xf6
    v_bitop3_b32 v12, v12, v68, s50 bitop3:0xf6
    v_bitop3_b32 v12, v12, v69, s51 bitop3:0xf6
    v_bitop3_b32 v12, v12, v70, s52 bitop3:0xf6
    v_bitop3_b32 v12, v12, v71, s53 bitop3:0xf6
    v_bitop3_b32 v12, v12, v72, s50 bitop3:0xf6
    v_bitop3_b32 v12, v12, v73, s51 bitop3:0xf6
    v_bitop3_b32 v12, v12, v74, s52 bitop3:0xf6
    v_bitop3_b32 v12, v12, v75, s53 bitop3:0xf6
    v_bitop3_b32 v12, v12, v76, s50 bitop3:0xf6
    v_bitop3_b32 v12, v12, v77, s51 bitop3:0xf6
    v_bitop3_b32 v12, v12, v78, s52 bitop3:0xf6
    v_bitop3_b32 v12, v12, v79, s53 bitop3:0xf6
    v_and_b32 v12, v7, v12
    v_cmp_ne_u32 vcc, 0, v12
    s_nop 0
    s_cbranch_vccnz H1_RETRY
    v_mfma_f32_16x16x32_bf16 v[20:23], a[0:3], v[64:67], 0
    v_mfma_f32_16x16x32_bf16 v[24:27], a[16:19], v[64:67], 0
    v_mfma_f32_16x16x32_bf16 v[28:31], a[32:35], v[64:67], 0
    v_mfma_f32_16x16x32_bf16 v[32:35], a[48:51], v[64:67], 0
    v_mfma_f32_16x16x32_bf16 v[20:23], a[4:7], v[68:71], v[20:23]
    v_mfma_f32_16x16x32_bf16 v[24:27], a[20:23], v[68:71], v[24:27]
    v_mfma_f32_16x16x32_bf16 v[28:31], a[36:39], v[68:71], v[28:31]
    v_mfma_f32_16x16x32_bf16 v[32:35], a[52:55], v[68:71], v[32:35]
    v_mfma_f32_16x16x32_bf16 v[20:23], a[8:11], v[72:75], v[20:23]
    v_mfma_f32_16x16x32_bf16 v[24:27], a[24:27], v[72:75], v[24:27]
    v_mfma_f32_16x16x32_bf16 v[28:31], a[40:43], v[72:75], v[28:31]
    v_mfma_f32_16x16x32_bf16 v[32:35], a[56:59], v[72:75], v[32:35]
    v_mfma_f32_16x16x32_bf16 v[20:23], a[12:15], v[76:79], v[20:23]
    v_mfma_f32_16x16x32_bf16 v[24:27], a[28:31], v[76:79], v[24:27]
    v_mfma_f32_16x16x32_bf16 v[28:31], a[44:47], v[76:79], v[28:31]
    v_mfma_f32_16x16x32_bf16 v[32:35], a[60:63], v[76:79], v[32:35]
    s_nop 4
    v_add_f32_dpp v20, v20, v20 row_ror:8 row_mask:0xf bank_mask:0xf
    v_add_f32_dpp v21, v21, v21 row_ror:8 row_mask:0xf bank_mask:0xf
    v_add_f32_dpp v22, v22, v22 row_ror:8 row_mask:0xf bank_mask:0xf
    v_add_f32_dpp v23, v23, v23 row_ror:8 row_mask:0xf bank_mask:0xf
    v_add_f32_dpp v24, v24, v24 row_ror:8 row_mask:0xf bank_mask:0xf
    v_add_f32_dpp v25, v25, v25 row_ror:8 row_mask:0xf bank_mask:0xf
    v_add_f32_dpp v26, v26, v26 row_ror:8 row_mask:0xf bank_mask:0xf
    v_add_f32_dpp v27, v27, v27 row_ror:8 row_mask:0xf bank_mask:0xf
    v_add_f32_dpp v28, v28, v28 row_ror:8 row_mask:0xf bank_mask:0xf
    v_add_f32_dpp v29, v29, v29 row_ror:8 row_mask:0xf bank_mask:0xf
    v_add_f32_dpp v30, v30, v30 row_ror:8 row_mask:0xf bank_mask:0xf
    v_add_f32_dpp v31, v31, v31 row_ror:8 row_mask:0xf bank_mask:0xf
    v_add_f32_dpp v32, v32, v32 row_ror:8 row_mask:0xf bank_mask:0xf
    v_add_f32_dpp v33, v33, v33 row_ror:8 row_mask:0xf bank_mask:0xf
    v_add_f32_dpp v34, v34, v34 row_ror:8 row_mask:0xf bank_mask:0xf
    v_add_f32_dpp v35, v35, v35 row_ror:8 row_mask:0xf bank_mask:0xf
    v_add_f32_dpp v36, v20, v20 row_ror:12 row_mask:0xf bank_mask:0xf
    v_add_f32_dpp v37, v21, v21 row_ror:12 row_mask:0xf bank_mask:0xf
    v_add_f32_dpp v38, v22, v22 row_ror:12 row_mask:0xf bank_mask:0xf
    v_add_f32_dpp v39, v23, v23 row_ror:12 row_mask:0xf bank_mask:0xf
    v_add_f32_dpp v40, v24, v24 row_ror:12 row_mask:0xf bank_mask:0xf
    v_add_f32_dpp v41, v25, v25 row_ror:12 row_mask:0xf bank_mask:0xf
    v_add_f32_dpp v42, v26, v26 row_ror:12 row_mask:0xf bank_mask:0xf
    v_add_f32_dpp v43, v27, v27 row_ror:12 row_mask:0xf bank_mask:0xf
    v_add_f32_dpp v36, v28, v28 row_ror:4 row_mask:0xf bank_mask:0xa
    v_add_f32_dpp v37, v29, v29 row_ror:4 row_mask:0xf bank_mask:0xa
    v_add_f32_dpp v38, v30, v30 row_ror:4 row_mask:0xf bank_mask:0xa
    v_add_f32_dpp v39, v31, v31 row_ror:4 row_mask:0xf bank_mask:0xa
    v_add_f32_dpp v40, v32, v32 row_ror:4 row_mask:0xf bank_mask:0xa
    v_add_f32_dpp v41, v33, v33 row_ror:4 row_mask:0xf bank_mask:0xa
    v_add_f32_dpp v42, v34, v34 row_ror:4 row_mask:0xf bank_mask:0xa
    v_add_f32_dpp v43, v35, v35 row_ror:4 row_mask:0xf bank_mask:0xa
    v_cvt_pk_bf16_f32 v44, v36, v37
    v_cvt_pk_bf16_f32 v45, v38, v39
    v_cvt_pk_bf16_f32 v46, v40, v41
    v_cvt_pk_bf16_f32 v47, v42, v43
    v_bfi_b32 v44, v7, s50, v44
    v_bfi_b32 v45, v7, s51, v45
    v_bfi_b32 v46, v7, s52, v46
    v_bfi_b32 v47, v7, s53, v47
    s_mov_b32 exec_lo, 0x00ff00ff
    s_mov_b32 exec_hi, 0x00ff00ff
    buffer_store_dwordx4 v[44:47], v9, s[44:47], s66 offen sc1
    s_mov_b64 exec, -1
    v_lshrrev_b32 v8, 3, v1
    v_lshlrev_b32 v8, 10, v8
    v_and_b32 v9, 7, v1
    v_xor_b32 v9, v9, v3
    v_lshl_add_u32 v14, v9, 4, v8
    v_xor_b32 v9, 4, v9
    v_lshl_add_u32 v15, v9, 4, v8
    v_add_u32 v15, 8192, v15
    s_lshl_b32 s67, s57, 1
    s_add_u32 s67, s67, s58
    s_lshl_b32 s67, s67, 14
    s_lshl_b32 s64, s48, 8
    s_add_u32 s67, s67, s64
    s_add_u32 s67, s67, 7340032
    s_lshl_b32 s68, s48, 12
    s_add_u32 s68, s68, 135168
    s_lshl_b32 s64, s48, 5
    v_add_u32 v8, s64, v2
    v_mul_u32_u24 v8, 1056, v8
    v_lshl_add_u32 v96, v3, 4, v8
    v_lshrrev_b32 v8, 1, v2
    v_xor_b32 v8, v8, v3
    v_lshlrev_b32 v9, 7, v2
    v_add_u32 v9, 135168, v9
    v_lshl_add_u32 v99, v8, 4, v9
    v_xor_b32 v8, 4, v8
    v_lshl_add_u32 v100, v8, 4, v9
    s_lshl_b32 s64, s48, 12
    s_add_u32 s64, s64, 135168
    v_lshlrev_b32 v9, 4, v1
    v_add_u32 v101, s64, v9
    v_lshlrev_b32 v8, 4, v2
    v_add_u32 v104, 160000, v8
    s_lshl_b32 s64, s48, 2
    v_add_u32 v103, s64, v104
    s_lshl_b32 s64, s48, 10
    s_add_u32 s64, s64, 155904
    v_add_u32 v105, s64, v9
    v_lshlrev_b32 v111, 4, v2
    s_lshl_b32 s77, s60, 9
    s_lshl_b32 s64, s58, 8
    s_add_u32 s77, s77, s64
    s_add_u32 s77, s77, 1835008
    v_lshlrev_b32 v8, 2, v1
    v_add_u32 v8, 160000, v8
    v_mov_b32 v9, -1
    ds_write_b32 v8, v9
    ds_write_b32 v8, v9 offset:512
    s_waitcnt vmcnt(0)
    v_mov_b32 v8, 161072
    ds_write_b32 v8, v13
    s_branch H2_ISSUE
A_HELP:
    s_lshl_b32 s64, s48, 5
    v_add_u32 v8, s64, v2
    v_mul_u32_u24 v8, 1056, v8
    v_lshl_add_u32 v96, v3, 4, v8
    v_lshrrev_b32 v8, 1, v2
    v_xor_b32 v8, v8, v3
    v_lshlrev_b32 v9, 7, v2
    v_add_u32 v9, 135168, v9
    v_lshl_add_u32 v99, v8, 4, v9
    v_xor_b32 v8, 4, v8
    v_lshl_add_u32 v100, v8, 4, v9
    s_lshl_b32 s64, s48, 12
    s_add_u32 s64, s64, 135168
    v_lshlrev_b32 v9, 4, v1
    v_add_u32 v101, s64, v9
    v_lshlrev_b32 v8, 4, v2
    v_add_u32 v104, 160000, v8
    s_lshl_b32 s64, s48, 2
    v_add_u32 v103, s64, v104
    s_lshl_b32 s64, s48, 10
    s_add_u32 s64, s64, 155904
    v_add_u32 v105, s64, v9
    v_lshlrev_b32 v111, 4, v2
    s_lshl_b32 s77, s60, 9
    s_lshl_b32 s64, s58, 8
    s_add_u32 s77, s77, s64
    s_add_u32 s77, s77, 1835008
    v_lshlrev_b32 v8, 2, v1
    v_add_u32 v8, 160000, v8
    v_mov_b32 v9, -1
    ds_write_b32 v8, v9
    ds_write_b32 v8, v9 offset:512
    v_lshrrev_b32 v8, 3, v1
    v_lshlrev_b32 v8, 10, v8
    v_and_b32 v9, 7, v1
    v_xor_b32 v9, v9, v3
    v_lshl_add_u32 v14, v9, 4, v8
    v_xor_b32 v9, 4, v9
    v_lshl_add_u32 v15, v9, 4, v8
    v_add_u32 v15, 8192, v15
    s_lshl_b32 s67, s57, 1
    s_add_u32 s67, s67, s58
    s_lshl_b32 s67, s67, 14
    s_lshl_b32 s64, s48, 8
    s_add_u32 s67, s67, s64
    s_add_u32 s67, s67, 7340032
    s_lshl_b32 s68, s48, 12
    s_add_u32 s68, s68, 135168
    v_mov_b32 v12, 161072
A_SPIN:
    ds_read_b32 v13, v12
    s_add_u32 s78, s78, 1
    s_cmp_gt_u32 s78, 0x200000
    s_cbranch_scc1 FAIL
    s_waitcnt lgkmcnt(0)
    v_cmp_eq_u32 vcc, 0, v13
    s_nop 0
    s_cbranch_vccnz A_SPIN
H2_ISSUE:
    s_add_u32 s64, s68, 0
    s_mov_b32 m0, s64
    s_add_u32 s65, s67, 0
    buffer_load_dwordx4 v14, s[44:47], s65 offen sc1 lds
    s_add_u32 s64, s68, 1024
    s_mov_b32 m0, s64
    s_add_u32 s65, s67, 0
    buffer_load_dwordx4 v15, s[44:47], s65 offen sc1 lds
    s_add_u32 s64, s68, 2048
    s_mov_b32 m0, s64
    s_add_u32 s65, s67, 128
    buffer_load_dwordx4 v14, s[44:47], s65 offen sc1 lds
    s_add_u32 s64, s68, 3072
    s_mov_b32 m0, s64
    s_add_u32 s65, s67, 128
    buffer_load_dwordx4 v15, s[44:47], s65 offen sc1 lds
JOIN_X1:
    s_waitcnt lgkmcnt(0)
    s_barrier
    s_cmp_ge_u32 s48, 4
    s_cbranch_scc1 B_V
    ds_read_b128 a[0:3], v96 offset:0
    ds_read_b128 a[4:7], v96 offset:64
    ds_read_b128 a[8:11], v96 offset:128
    ds_read_b128 a[12:15], v96 offset:192
    ds_read_b128 a[16:19], v96 offset:256
    ds_read_b128 a[20:23], v96 offset:320
    ds_read_b128 a[24:27], v96 offset:384
    ds_read_b128 a[28:31], v96 offset:448
    s_waitcnt lgkmcnt(6)
    ds_read_b128 a[32:35], v96 offset:512
    ds_read_b128 a[36:39], v96 offset:576
    ds_read_b128 a[40:43], v96 offset:640
    ds_read_b128 a[44:47], v96 offset:704
    ds_read_b128 a[48:51], v96 offset:768
    ds_read_b128 a[52:55], v96 offset:832
    ds_read_b128 a[56:59], v96 offset:896
    ds_read_b128 a[60:63], v96 offset:960
    s_waitcnt lgkmcnt(6)
    ds_read_b128 a[64:67], v96 offset:16896
    ds_read_b128 a[68:71], v96 offset:16960
    ds_read_b128 a[72:75], v96 offset:17024
    ds_read_b128 a[76:79], v96 offset:17088
    ds_read_b128 a[80:83], v96 offset:17152
    ds_read_b128 a[84:87], v96 offset:17216
    ds_read_b128 a[88:91], v96 offset:17280
    ds_read_b128 a[92:95], v96 offset:17344
    s_waitcnt lgkmcnt(6)
    ds_read_b128 a[96:99], v96 offset:17408
    ds_read_b128 a[100:103], v96 offset:17472
    ds_read_b128 a[104:107], v96 offset:17536
    ds_read_b128 a[108:111], v96 offset:17600
    ds_read_b128 a[112:115], v96 offset:17664
    ds_read_b128 a[116:119], v96 offset:17728
    ds_read_b128 a[120:123], v96 offset:17792
    ds_read_b128 a[124:127], v96 offset:17856
    s_waitcnt lgkmcnt(6)
Q_CHECK:
    s_waitcnt vmcnt(0)
    ds_read_b128 v[64:67], v101 offset:0
    ds_read_b128 v[68:71], v101 offset:1024
    ds_read_b128 v[72:75], v101 offset:2048
    ds_read_b128 v[76:79], v101 offset:3072
    v_mov_b32 v20, 0
    s_waitcnt lgkmcnt(3)
    v_bitop3_b32 v20, v20, v64, s50 bitop3:0xf6
    v_bitop3_b32 v20, v20, v65, s51 bitop3:0xf6
    v_bitop3_b32 v20, v20, v66, s52 bitop3:0xf6
    v_bitop3_b32 v20, v20, v67, s53 bitop3:0xf6
    s_waitcnt lgkmcnt(2)
    v_bitop3_b32 v20, v20, v68, s50 bitop3:0xf6
    v_bitop3_b32 v20, v20, v69, s51 bitop3:0xf6
    v_bitop3_b32 v20, v20, v70, s52 bitop3:0xf6
    v_bitop3_b32 v20, v20, v71, s53 bitop3:0xf6
    s_waitcnt lgkmcnt(1)
    v_bitop3_b32 v20, v20, v72, s50 bitop3:0xf6
    v_bitop3_b32 v20, v20, v73, s51 bitop3:0xf6
    v_bitop3_b32 v20, v20, v74, s52 bitop3:0xf6
    v_bitop3_b32 v20, v20, v75, s53 bitop3:0xf6
    s_waitcnt lgkmcnt(0)
    v_bitop3_b32 v20, v20, v76, s50 bitop3:0xf6
    v_bitop3_b32 v20, v20, v77, s51 bitop3:0xf6
    v_bitop3_b32 v20, v20, v78, s52 bitop3:0xf6
    v_bitop3_b32 v20, v20, v79, s53 bitop3:0xf6
    v_and_b32 v20, v7, v20
    v_cmp_ne_u32 vcc, 0, v20
    s_nop 0
    s_cbranch_vccnz Q_RETRY
    s_barrier
    ds_read_b128 v[64:67], v99 offset:0
    ds_read_b128 v[68:71], v100 offset:0
    ds_read_b128 v[72:75], v99 offset:2048
    ds_read_b128 v[76:79], v100 offset:2048
    ds_read_b128 v[80:83], v99 offset:4096
    ds_read_b128 v[84:87], v100 offset:4096
    ds_read_b128 v[88:91], v99 offset:6144
    ds_read_b128 v[92:95], v100 offset:6144
    s_waitcnt lgkmcnt(7)
    v_mfma_f32_16x16x32_bf16 v[16:19], a[0:3], v[64:67], 0
    v_mfma_f32_16x16x32_bf16 v[20:23], a[64:67], v[64:67], 0
    ds_read_b128 v[64:67], v99 offset:8192
    s_waitcnt lgkmcnt(7)
    v_mfma_f32_16x16x32_bf16 v[16:19], a[4:7], v[68:71], v[16:19]
    v_mfma_f32_16x16x32_bf16 v[20:23], a[68:71], v[68:71], v[20:23]
    ds_read_b128 v[68:71], v100 offset:8192
    s_waitcnt lgkmcnt(7)
    v_mfma_f32_16x16x32_bf16 v[16:19], a[8:11], v[72:75], v[16:19]
    v_mfma_f32_16x16x32_bf16 v[20:23], a[72:75], v[72:75], v[20:23]
    ds_read_b128 v[72:75], v99 offset:10240
    s_waitcnt lgkmcnt(7)
    v_mfma_f32_16x16x32_bf16 v[16:19], a[12:15], v[76:79], v[16:19]
    v_mfma_f32_16x16x32_bf16 v[20:23], a[76:79], v[76:79], v[20:23]
    ds_read_b128 v[76:79], v100 offset:10240
    s_waitcnt lgkmcnt(7)
    v_mfma_f32_16x16x32_bf16 v[16:19], a[16:19], v[80:83], v[16:19]
    v_mfma_f32_16x16x32_bf16 v[20:23], a[80:83], v[80:83], v[20:23]
    ds_read_b128 v[80:83], v99 offset:12288
    s_waitcnt lgkmcnt(7)
    v_mfma_f32_16x16x32_bf16 v[16:19], a[20:23], v[84:87], v[16:19]
    v_mfma_f32_16x16x32_bf16 v[20:23], a[84:87], v[84:87], v[20:23]
    ds_read_b128 v[84:87], v100 offset:12288
    s_waitcnt lgkmcnt(7)
    v_mfma_f32_16x16x32_bf16 v[16:19], a[24:27], v[88:91], v[16:19]
    v_mfma_f32_16x16x32_bf16 v[20:23], a[88:91], v[88:91], v[20:23]
    ds_read_b128 v[88:91], v99 offset:14336
    s_waitcnt lgkmcnt(7)
    v_mfma_f32_16x16x32_bf16 v[16:19], a[28:31], v[92:95], v[16:19]
    v_mfma_f32_16x16x32_bf16 v[20:23], a[92:95], v[92:95], v[20:23]
    ds_read_b128 v[92:95], v100 offset:14336
    s_waitcnt lgkmcnt(7)
    v_mfma_f32_16x16x32_bf16 v[16:19], a[32:35], v[64:67], v[16:19]
    v_mfma_f32_16x16x32_bf16 v[20:23], a[96:99], v[64:67], v[20:23]
    s_waitcnt lgkmcnt(6)
    v_mfma_f32_16x16x32_bf16 v[16:19], a[36:39], v[68:71], v[16:19]
    v_mfma_f32_16x16x32_bf16 v[20:23], a[100:103], v[68:71], v[20:23]
    s_waitcnt lgkmcnt(5)
    v_mfma_f32_16x16x32_bf16 v[16:19], a[40:43], v[72:75], v[16:19]
    v_mfma_f32_16x16x32_bf16 v[20:23], a[104:107], v[72:75], v[20:23]
    s_waitcnt lgkmcnt(4)
    v_mfma_f32_16x16x32_bf16 v[16:19], a[44:47], v[76:79], v[16:19]
    v_mfma_f32_16x16x32_bf16 v[20:23], a[108:111], v[76:79], v[20:23]
    s_waitcnt lgkmcnt(3)
    v_mfma_f32_16x16x32_bf16 v[16:19], a[48:51], v[80:83], v[16:19]
    v_mfma_f32_16x16x32_bf16 v[20:23], a[112:115], v[80:83], v[20:23]
    s_waitcnt lgkmcnt(2)
    v_mfma_f32_16x16x32_bf16 v[16:19], a[52:55], v[84:87], v[16:19]
    v_mfma_f32_16x16x32_bf16 v[20:23], a[116:119], v[84:87], v[20:23]
    s_waitcnt lgkmcnt(1)
    v_mfma_f32_16x16x32_bf16 v[16:19], a[56:59], v[88:91], v[16:19]
    v_mfma_f32_16x16x32_bf16 v[20:23], a[120:123], v[88:91], v[20:23]
    s_waitcnt lgkmcnt(0)
    v_mfma_f32_16x16x32_bf16 v[16:19], a[60:63], v[92:95], v[16:19]
    v_mfma_f32_16x16x32_bf16 v[20:23], a[124:127], v[92:95], v[20:23]
    s_nop 6
    v_max3_f32 v24, v16, v17, v18
    v_max3_f32 v25, v19, v20, v21
    v_max3_f32 v24, v24, v22, v23
    v_max_f32 v24, v24, v25
    v_mov_b32 v25, v24
    s_nop 1
    v_permlane16_swap_b32 v25, v24
    v_max_f32 v24, v24, v25
    v_mov_b32 v25, v24
    s_nop 1
    v_permlane32_swap_b32 v25, v24
    v_max_f32 v24, v24, v25
    ds_write_b32 v103, v24
M_SPIN:
    ds_read_b128 v[24:27], v104
    s_add_u32 s78, s78, 1
    s_cmp_gt_u32 s78, 0x200000
    s_cbranch_scc1 FAIL
    s_waitcnt lgkmcnt(0)
    v_max3_u32 v28, v24, v25, v26
    v_max_u32 v28, v28, v27
    v_cmp_eq_u32 vcc, -1, v28
    s_nop 0
    s_cbranch_vccnz M_SPIN
    v_max3_f32 v24, v24, v25, v26
    v_max_f32 v31, v24, v27
    v_sub_f32 v16, v16, v31
    v_sub_f32 v17, v17, v31
    v_sub_f32 v18, v18, v31
    v_sub_f32 v19, v19, v31
    v_sub_f32 v20, v20, v31
    v_sub_f32 v21, v21, v31
    v_sub_f32 v22, v22, v31
    v_sub_f32 v23, v23, v31
    v_exp_f32 v16, v16
    v_exp_f32 v17, v17
    v_exp_f32 v18, v18
    v_exp_f32 v19, v19
    v_exp_f32 v20, v20
    v_exp_f32 v21, v21
    v_exp_f32 v22, v22
    v_exp_f32 v23, v23
    v_cvt_pk_bf16_f32 v24, v16, v17
    v_cvt_pk_bf16_f32 v25, v18, v19
    v_cvt_pk_bf16_f32 v26, v20, v21
    v_cvt_pk_bf16_f32 v27, v22, v23
    ds_write_b128 v105, v[24:27]
    v_add_f32 v16, v16, v17
    v_add_f32 v18, v18, v19
    v_add_f32 v20, v20, v21
    v_add_f32 v22, v22, v23
    v_add_f32 v16, v16, v18
    v_add_f32 v20, v20, v22
    v_add_f32 v16, v16, v20
    s_waitcnt lgkmcnt(0)
    s_barrier
    v_mov_b32 v17, v16
    s_nop 1
    v_permlane16_swap_b32 v17, v16
    v_add_f32 v16, v16, v17
    v_mov_b32 v17, v16
    s_nop 1
    v_permlane32_swap_b32 v17, v16
    v_add_f32 v16, v16, v17
    ds_write_b32 v103, v16 offset:512
    s_cmp_lg_u32 s48, 0
    s_cbranch_scc1 NOSTAT_1
L_SPIN:
    ds_read_b128 v[24:27], v104 offset:512
    s_add_u32 s78, s78, 1
    s_cmp_gt_u32 s78, 0x200000
    s_cbranch_scc1 FAIL
    s_waitcnt lgkmcnt(0)
    v_max3_u32 v28, v24, v25, v26
    v_max_u32 v28, v28, v27
    v_cmp_eq_u32 vcc, -1, v28
    s_nop 0
    s_cbranch_vccnz L_SPIN
    v_add_f32 v24, v24, v25
    v_add_f32 v26, v26, v27
    v_add_f32 v26, v24, v26
    v_mov_b32 v24, v31
    v_mov_b32 v25, s54
    v_mov_b32 v27, s54
    s_mov_b64 exec, 0xffff
    buffer_store_dwordx4 v[24:27], v111, s[44:47], s77 offen sc1
    s_mov_b64 exec, -1
NOSTAT_1:
    s_cmp_eq_u32 s79, 1
    s_cbranch_scc1 PR_2
    s_cmp_eq_u32 s79, 2
    s_cbranch_scc1 PR_3
    s_cmp_eq_u32 s79, 3
    s_cbranch_scc1 PR_4
    s_and_b32 s67, s48, 3
    s_lshr_b32 s68, s48, 2
    v_and_b32 v8, 31, v1
    v_lshlrev_b32 v100, 9, v8
    s_lshl_b32 s73, s67, 14
    s_lshl_b32 s64, s55, 4
    s_add_u32 s73, s73, s64
    s_add_u32 s73, s73, 1835008
    v_lshrrev_b32 v8, 3, v1
    v_lshlrev_b32 v8, 7, v8
    v_bfe_u32 v9, v1, 1, 2
    v_xor_b32 v9, v9, v3
    v_lshl_add_u32 v8, v9, 5, v8
    v_and_b32 v9, 1, v1
    v_lshl_add_u32 v101, v9, 4, v8
    s_lshl_b32 s74, s55, 2
    s_add_u32 s74, s74, s56
    s_lshl_b32 s74, s74, 1
    s_add_u32 s74, s74, s68
    s_mul_i32 s74, s74, 16768
    s_lshl_b32 s64, s67, 12
    s_add_u32 s74, s74, s64
    s_add_u32 s74, s74, 2097152
    s_lshl_b32 s75, s48, 12
    s_add_u32 s75, s75, 32768
    v_lshrrev_b32 v8, 2, v2
    v_lshl_add_u32 v8, v3, 2, v8
    v_bfe_u32 v9, v8, 1, 2
    v_lshlrev_b32 v9, 5, v9
    v_lshl_add_u32 v9, v8, 7, v9
    v_and_b32 v8, 3, v1
    v_lshl_add_u32 v9, v8, 3, v9
    v_add_u32 v102, s75, v9
    v_xor_b32 v103, 32, v102
    v_xor_b32 v104, 64, v102
    v_xor_b32 v105, 96, v102
    s_lshl_b32 s65, s67, 6
    s_add_u32 s65, s65, 161088
    v_and_b32 v8, 31, v1
    v_lshl_add_u32 v122, v8, 1, s65
    v_lshl_add_u32 v123, v3, 3, s65
    v_and_b32 v8, 1, v3
    v_lshrrev_b32 v9, 2, v2
    v_lshl_add_u32 v10, v8, 2, v9
    v_lshlrev_b32 v10, 5, v10
    v_lshl_add_u32 v9, v8, 4, v9
    v_lshrrev_b32 v8, 1, v3
    v_lshl_add_u32 v9, v8, 2, v9
    v_lshl_add_u32 v10, v9, 8, v10
    v_and_b32 v8, 3, v1
    v_lshl_add_u32 v10, v8, 3, v10
    s_lshl_b32 s64, s68, 7
    v_xor_b32 v10, s64, v10
    s_lshl_b32 s64, s68, 14
    v_add_u32 v117, s64, v10
    s_xor_b32 s64, s64, 16384
    v_add_u32 v118, s64, v10
    s_lshl_b32 s64, s67, 1
    s_add_u32 s64, s64, s68
    s_lshl_b32 s65, s64, 7
    s_add_u32 s65, s65, 155904
    v_lshl_add_u32 v119, v3, 5, s65
    s_xor_b32 s64, s64, 1
    s_lshl_b32 s65, s64, 7
    s_add_u32 s65, s65, 155904
    v_lshl_add_u32 v120, v3, 5, s65
    v_lshrrev_b32 v8, 2, v2
    v_lshlrev_b32 v8, 6, v8
    v_lshl_add_u32 v121, v3, 4, v8
    s_lshl_b32 s72, s55, 2
    s_add_u32 s72, s72, s56
    s_lshl_b32 s72, s72, 2
    s_add_u32 s72, s72, s67
    s_lshl_b32 s72, s72, 1
    s_add_u32 s72, s72, s68
    s_lshl_b32 s72, s72, 7
    s_add_u32 s72, s72, 393216
    s_branch PR_4
PR_2:
    v_lshrrev_b32 v8, 2, v2
    v_lshlrev_b32 v8, 10, v8
    v_and_b32 v9, 3, v2
    v_lshl_add_u32 v8, v9, 8, v8
    v_lshl_add_u32 v100, v3, 4, v8
    s_lshl_b32 s73, s48, 3
    s_add_u32 s73, s73, s62
    s_lshl_b32 s73, s73, 12
    s_add_u32 s73, s73, 393216
    s_lshl_b32 s64, s48, 14
    s_add_u32 s64, s64, 0
    v_lshrrev_b32 v8, 2, v2
    v_lshl_add_u32 v8, v3, 2, v8
    v_bfe_u32 v9, v8, 1, 2
    v_lshlrev_b32 v9, 5, v9
    v_lshl_add_u32 v9, v8, 7, v9
    v_and_b32 v8, 3, v1
    v_lshl_add_u32 v9, v8, 3, v9
    v_add_u32 v102, s64, v9
    v_xor_b32 v103, 32, v102
    v_xor_b32 v104, 64, v102
    v_xor_b32 v105, 96, v102
    v_lshlrev_b32 v8, 4, v1
    v_add_u32 v115, 155904, v8
    s_lshl_b32 s64, s48, 10
    v_add_u32 v114, s64, v115
    v_lshrrev_b32 v8, 2, v2
    v_lshlrev_b32 v8, 10, v8
    v_and_b32 v9, 3, v2
    v_lshl_add_u32 v8, v9, 5, v8
    v_lshl_add_u32 v101, v3, 3, v8
    s_lshl_b32 s75, s61, 5
    s_add_u32 s75, s75, s62
    s_lshl_b32 s75, s75, 7
    s_add_u32 s75, s75, 655360
    s_branch PR_4
PR_3:
    v_lshlrev_b32 v116, 3, v1
    v_and_b32 v8, 3, v2
    v_and_b32 v9, 1, v8
    v_lshlrev_b32 v9, 4, v9
    v_mov_b32 v10, 0x3f80
    v_lshlrev_b32 v10, v9, v10
    v_cmp_gt_u32 vcc, 2, v8
    s_nop 1
    v_cndmask_b32 v104, 0, v10, vcc
    v_cndmask_b32 v105, v10, 0, vcc
    v_mov_b32 v106, v104
    v_mov_b32 v107, v105
    v_lshrrev_b32 v8, 2, v2
    v_lshl_add_u32 v8, v3, 2, v8
    v_bfe_u32 v9, v8, 2, 1
    v_lshlrev_b32 v9, 5, v9
    v_lshl_add_u32 v9, v8, 6, v9
    v_and_b32 v8, 3, v1
    v_lshl_add_u32 v9, v8, 3, v9
    s_lshl_b32 s64, s48, 12
    s_add_u32 s64, s64, 0
    v_add_u32 v119, s64, v9
    v_xor_b32 v121, 32, v119
    v_lshrrev_b32 v9, 2, v2
    v_lshl_add_u32 v9, v3, 2, v9
    v_mul_u32_u24 v9, 1056, v9
    v_and_b32 v10, 3, v1
    v_lshl_add_u32 v9, v10, 3, v9
    s_lshl_b32 s64, s48, 7
    s_add_u32 s64, s64, 65536
    v_add_u32 v120, s64, v9
    s_lshl_b32 s73, s48, 12
    s_add_u32 s74, s73, 99328
    s_add_u32 s73, s73, 655360
    v_lshlrev_b32 v108, 4, v1
    v_add_u32 v109, s74, v116
    v_and_b32 v8, 3, v2
    v_lshlrev_b32 v8, 6, v8
    s_lshl_b32 s64, s48, 3
    s_add_u32 s64, s64, 160000
    v_add_u32 v110, s64, v8
    v_lshrrev_b32 v9, 2, v2
    v_lshl_add_u32 v8, v9, 4, v8
    v_add_u32 v111, 160000, v8
    v_and_b32 v8, 3, v2
    v_lshl_add_u32 v8, v3, 4, v8
    v_lshlrev_b32 v8, 4, v8
    s_lshr_b32 s64, s48, 2
    s_lshl_b32 s64, s64, 10
    s_and_b32 s65, s48, 3
    s_lshl_b32 s65, s65, 6
    s_add_u32 s64, s64, s65
    s_add_u32 s64, s64, 143360
    v_add_u32 v112, s64, v8
    v_lshlrev_b32 v8, 4, v1
    v_add_u32 v113, 143360, v8
    v_add_u32 v117, 135168, v8
    v_lshrrev_b32 v8, 2, v2
    v_mul_u32_u24 v8, 5504, v8
    v_and_b32 v9, 3, v2
    v_lshl_add_u32 v8, v9, 5, v8
    v_lshl_add_u32 v118, v3, 3, v8
    s_mul_i32 s75, s48, 22016
    s_lshl_b32 s64, s63, 7
    s_add_u32 s75, s75, s64
    s_add_u32 s75, s75, 720896
PR_4:
    s_branch B_END
B_V:
    ds_read_b64_tr_b16 a[0:1], v97 offset:0
    ds_read_b64_tr_b16 a[2:3], v97 offset:16896
    ds_read_b64_tr_b16 a[16:17], v97 offset:32
    ds_read_b64_tr_b16 a[18:19], v97 offset:16928
    ds_read_b64_tr_b16 a[32:33], v97 offset:64
    ds_read_b64_tr_b16 a[34:35], v97 offset:16960
    ds_read_b64_tr_b16 a[48:49], v97 offset:96
    ds_read_b64_tr_b16 a[50:51], v97 offset:16992
    s_waitcnt lgkmcnt(6)
    ds_read_b64_tr_b16 a[64:65], v97 offset:128
    ds_read_b64_tr_b16 a[66:67], v97 offset:17024
    ds_read_b64_tr_b16 a[80:81], v97 offset:160
    ds_read_b64_tr_b16 a[82:83], v97 offset:17056
    ds_read_b64_tr_b16 a[96:97], v97 offset:192
    ds_read_b64_tr_b16 a[98:99], v97 offset:17088
    ds_read_b64_tr_b16 a[112:113], v97 offset:224
    ds_read_b64_tr_b16 a[114:115], v97 offset:17120
    s_waitcnt lgkmcnt(6)
    ds_read_b64_tr_b16 a[4:5], v97 offset:33792
    ds_read_b64_tr_b16 a[6:7], v97 offset:50688
    ds_read_b64_tr_b16 a[20:21], v97 offset:33824
    ds_read_b64_tr_b16 a[22:23], v97 offset:50720
    ds_read_b64_tr_b16 a[36:37], v97 offset:33856
    ds_read_b64_tr_b16 a[38:39], v97 offset:50752
    ds_read_b64_tr_b16 a[52:53], v97 offset:33888
    ds_read_b64_tr_b16 a[54:55], v97 offset:50784
    s_waitcnt lgkmcnt(6)
    ds_read_b64_tr_b16 a[68:69], v97 offset:33920
    ds_read_b64_tr_b16 a[70:71], v97 offset:50816
    ds_read_b64_tr_b16 a[84:85], v97 offset:33952
    ds_read_b64_tr_b16 a[86:87], v97 offset:50848
    ds_read_b64_tr_b16 a[100:101], v97 offset:33984
    ds_read_b64_tr_b16 a[102:103], v97 offset:50880
    ds_read_b64_tr_b16 a[116:117], v97 offset:34016
    ds_read_b64_tr_b16 a[118:119], v97 offset:50912
    s_waitcnt lgkmcnt(6)
    ds_read_b64_tr_b16 a[8:9], v98 offset:0
    ds_read_b64_tr_b16 a[10:11], v98 offset:16896
    ds_read_b64_tr_b16 a[24:25], v98 offset:32
    ds_read_b64_tr_b16 a[26:27], v98 offset:16928
    ds_read_b64_tr_b16 a[40:41], v98 offset:64
    ds_read_b64_tr_b16 a[42:43], v98 offset:16960
    ds_read_b64_tr_b16 a[56:57], v98 offset:96
    ds_read_b64_tr_b16 a[58:59], v98 offset:16992
    s_waitcnt lgkmcnt(6)
    ds_read_b64_tr_b16 a[72:73], v98 offset:128
    ds_read_b64_tr_b16 a[74:75], v98 offset:17024
    ds_read_b64_tr_b16 a[88:89], v98 offset:160
    ds_read_b64_tr_b16 a[90:91], v98 offset:17056
    ds_read_b64_tr_b16 a[104:105], v98 offset:192
    ds_read_b64_tr_b16 a[106:107], v98 offset:17088
    ds_read_b64_tr_b16 a[120:121], v98 offset:224
    ds_read_b64_tr_b16 a[122:123], v98 offset:17120
    s_waitcnt lgkmcnt(6)
    ds_read_b64_tr_b16 a[12:13], v98 offset:33792
    ds_read_b64_tr_b16 a[14:15], v98 offset:50688
    ds_read_b64_tr_b16 a[28:29], v98 offset:33824
    ds_read_b64_tr_b16 a[30:31], v98 offset:50720
    ds_read_b64_tr_b16 a[44:45], v98 offset:33856
    ds_read_b64_tr_b16 a[46:47], v98 offset:50752
    ds_read_b64_tr_b16 a[60:61], v98 offset:33888
    ds_read_b64_tr_b16 a[62:63], v98 offset:50784
    s_waitcnt lgkmcnt(6)
    ds_read_b64_tr_b16 a[76:77], v98 offset:33920
    ds_read_b64_tr_b16 a[78:79], v98 offset:50816
    ds_read_b64_tr_b16 a[92:93], v98 offset:33952
    ds_read_b64_tr_b16 a[94:95], v98 offset:50848
    ds_read_b64_tr_b16 a[108:109], v98 offset:33984
    ds_read_b64_tr_b16 a[110:111], v98 offset:50880
    ds_read_b64_tr_b16 a[124:125], v98 offset:34016
    ds_read_b64_tr_b16 a[126:127], v98 offset:50912
    s_waitcnt lgkmcnt(0)
    s_barrier
    s_cmp_eq_u32 s79, 1
    s_cbranch_scc1 RD_5
    s_cmp_eq_u32 s79, 2
    s_cbranch_scc1 RD_6
    s_cmp_eq_u32 s79, 3
    s_cbranch_scc1 RD_7
    s_mov_b32 m0, s70
    s_add_u32 s70, s70, 1024
    buffer_load_dwordx4 v112, s[20:23], s69 offen nt lds
    s_add_u32 s69, s69, 32768
    s_mov_b32 m0, s70
    s_add_u32 s70, s70, 1024
    buffer_load_dwordx4 v112, s[20:23], s69 offen nt lds
    s_add_u32 s69, s69, 32768
    s_mov_b32 m0, s70
    s_add_u32 s70, s70, 1024
    buffer_load_dwordx4 v112, s[20:23], s69 offen nt lds
    s_add_u32 s69, s69, 32768
    s_mov_b32 m0, s70
    s_add_u32 s70, s70, 1024
    buffer_load_dwordx4 v112, s[20:23], s69 offen nt lds
    s_add_u32 s69, s69, 32768
    s_mov_b32 m0, s70
    s_add_u32 s70, s70, 1024
    buffer_load_dwordx4 v113, s[20:23], s69 offen nt lds
    s_add_u32 s69, s69, 32768
    s_mov_b32 m0, s70
    s_add_u32 s70, s70, 1024
    buffer_load_dwordx4 v113, s[20:23], s69 offen nt lds
    s_add_u32 s69, s69, 32768
    s_mov_b32 m0, s70
    s_add_u32 s70, s70, 1024
    buffer_load_dwordx4 v113, s[20:23], s69 offen nt lds
    s_add_u32 s69, s69, 32768
    s_mov_b32 m0, s70
    s_add_u32 s70, s70, 1024
    buffer_load_dwordx4 v113, s[20:23], s69 offen nt lds
    s_add_u32 s69, s69, 32768
    s_branch RD_7
RD_5:
    s_mov_b32 m0, s70
    s_add_u32 s70, s70, 1024
    buffer_load_dwordx4 v112, s[24:27], s69 offen nt lds
    s_add_u32 s69, s69, 8192
    s_mov_b32 m0, s70
    s_add_u32 s70, s70, 1024
    buffer_load_dwordx4 v112, s[24:27], s69 offen nt lds
    s_add_u32 s69, s69, 8192
    s_mov_b32 m0, s70
    s_add_u32 s70, s70, 1024
    buffer_load_dwordx4 v112, s[24:27], s69 offen nt lds
    s_add_u32 s69, s69, 8192
    s_mov_b32 m0, s70
    s_add_u32 s70, s70, 1024
    buffer_load_dwordx4 v112, s[24:27], s69 offen nt lds
    s_add_u32 s69, s69, 8192
    s_mov_b32 m0, s70
    s_add_u32 s70, s70, 1024
    buffer_load_dwordx4 v112, s[24:27], s69 offen nt lds
    s_add_u32 s69, s69, 8192
    s_mov_b32 m0, s70
    s_add_u32 s70, s70, 1024
    buffer_load_dwordx4 v112, s[24:27], s69 offen nt lds
    s_add_u32 s69, s69, 8192
    s_mov_b32 m0, s70
    s_add_u32 s70, s70, 1024
    buffer_load_dwordx4 v112, s[24:27], s69 offen nt lds
    s_add_u32 s69, s69, 8192
    s_mov_b32 m0, s70
    s_add_u32 s70, s70, 1024
    buffer_load_dwordx4 v112, s[24:27], s69 offen nt lds
    s_add_u32 s69, s69, 8192
    s_branch RD_7
RD_6:
    s_mov_b32 m0, s70
    s_add_u32 s67, s70, 32768
    buffer_load_dwordx4 v112, s[28:31], s69 offen nt lds
    s_mov_b32 m0, s67
    s_add_u32 s70, s70, 1024
    buffer_load_dwordx4 v112, s[32:35], s69 offen nt lds
    s_add_u32 s69, s69, 44032
    s_mov_b32 m0, s70
    s_add_u32 s67, s70, 32768
    buffer_load_dwordx4 v112, s[28:31], s69 offen nt lds
    s_mov_b32 m0, s67
    s_add_u32 s70, s70, 1024
    buffer_load_dwordx4 v112, s[32:35], s69 offen nt lds
    s_add_u32 s69, s69, 44032
RD_7:
    s_cmp_lg_u32 s79, 0
    s_cbranch_scc1 PV_8
    s_and_b32 s67, s48, 3
    s_lshr_b32 s68, s48, 2
    v_and_b32 v8, 31, v1
    v_lshlrev_b32 v100, 9, v8
    s_lshl_b32 s73, s67, 14
    s_lshl_b32 s64, s55, 4
    s_add_u32 s73, s73, s64
    s_add_u32 s73, s73, 1835008
    v_lshrrev_b32 v8, 3, v1
    v_lshlrev_b32 v8, 7, v8
    v_bfe_u32 v9, v1, 1, 2
    v_xor_b32 v9, v9, v3
    v_lshl_add_u32 v8, v9, 5, v8
    v_and_b32 v9, 1, v1
    v_lshl_add_u32 v101, v9, 4, v8
    s_lshl_b32 s74, s55, 2
    s_add_u32 s74, s74, s56
    s_lshl_b32 s74, s74, 1
    s_add_u32 s74, s74, s68
    s_mul_i32 s74, s74, 16768
    s_lshl_b32 s64, s67, 12
    s_add_u32 s74, s74, s64
    s_add_u32 s74, s74, 2097152
    s_lshl_b32 s75, s48, 12
    s_add_u32 s75, s75, 32768
    v_lshrrev_b32 v8, 2, v2
    v_lshl_add_u32 v8, v3, 2, v8
    v_bfe_u32 v9, v8, 1, 2
    v_lshlrev_b32 v9, 5, v9
    v_lshl_add_u32 v9, v8, 7, v9
    v_and_b32 v8, 3, v1
    v_lshl_add_u32 v9, v8, 3, v9
    v_add_u32 v102, s75, v9
    v_xor_b32 v103, 32, v102
    v_xor_b32 v104, 64, v102
    v_xor_b32 v105, 96, v102
    s_lshl_b32 s65, s67, 6
    s_add_u32 s65, s65, 161088
    v_and_b32 v8, 31, v1
    v_lshl_add_u32 v122, v8, 1, s65
    v_lshl_add_u32 v123, v3, 3, s65
    v_and_b32 v8, 1, v3
    v_lshrrev_b32 v9, 2, v2
    v_lshl_add_u32 v10, v8, 2, v9
    v_lshlrev_b32 v10, 5, v10
    v_lshl_add_u32 v9, v8, 4, v9
    v_lshrrev_b32 v8, 1, v3
    v_lshl_add_u32 v9, v8, 2, v9
    v_lshl_add_u32 v10, v9, 8, v10
    v_and_b32 v8, 3, v1
    v_lshl_add_u32 v10, v8, 3, v10
    s_lshl_b32 s64, s68, 7
    v_xor_b32 v10, s64, v10
    s_lshl_b32 s64, s68, 14
    v_add_u32 v117, s64, v10
    s_xor_b32 s64, s64, 16384
    v_add_u32 v118, s64, v10
    s_lshl_b32 s64, s67, 1
    s_add_u32 s64, s64, s68
    s_lshl_b32 s65, s64, 7
    s_add_u32 s65, s65, 155904
    v_lshl_add_u32 v119, v3, 5, s65
    s_xor_b32 s64, s64, 1
    s_lshl_b32 s65, s64, 7
    s_add_u32 s65, s65, 155904
    v_lshl_add_u32 v120, v3, 5, s65
    v_lshrrev_b32 v8, 2, v2
    v_lshlrev_b32 v8, 6, v8
    v_lshl_add_u32 v121, v3, 4, v8
    s_lshl_b32 s72, s55, 2
    s_add_u32 s72, s72, s56
    s_lshl_b32 s72, s72, 2
    s_add_u32 s72, s72, s67
    s_lshl_b32 s72, s72, 1
    s_add_u32 s72, s72, s68
    s_lshl_b32 s72, s72, 7
    s_add_u32 s72, s72, 393216
PV_8:
    s_barrier
    ds_read_b128 v[64:67], v106 offset:0
    ds_read_b128 v[68:71], v106 offset:1024
    ds_read_b128 v[72:75], v106 offset:2048
    ds_read_b128 v[76:79], v106 offset:3072
    s_mov_b32 vcc_lo, 0x00ff00ff
    s_mov_b32 vcc_hi, 0x00ff00ff
    s_not_b64 s[66:67], vcc
    s_waitcnt lgkmcnt(3)
    v_mfma_f32_16x16x32_bf16 v[32:35], a[0:3], v[64:67], 0
    v_mfma_f32_16x16x32_bf16 v[36:39], a[16:19], v[64:67], 0
    v_mfma_f32_16x16x32_bf16 v[40:43], a[32:35], v[64:67], 0
    v_mfma_f32_16x16x32_bf16 v[44:47], a[48:51], v[64:67], 0
    s_waitcnt lgkmcnt(2)
    v_mfma_f32_16x16x32_bf16 v[32:35], a[4:7], v[68:71], v[32:35]
    v_mfma_f32_16x16x32_bf16 v[36:39], a[20:23], v[68:71], v[36:39]
    v_mfma_f32_16x16x32_bf16 v[40:43], a[36:39], v[68:71], v[40:43]
    v_mfma_f32_16x16x32_bf16 v[44:47], a[52:55], v[68:71], v[44:47]
    s_waitcnt lgkmcnt(1)
    v_mfma_f32_16x16x32_bf16 v[32:35], a[8:11], v[72:75], v[32:35]
    v_mfma_f32_16x16x32_bf16 v[36:39], a[24:27], v[72:75], v[36:39]
    v_mfma_f32_16x16x32_bf16 v[40:43], a[40:43], v[72:75], v[40:43]
    v_mfma_f32_16x16x32_bf16 v[44:47], a[56:59], v[72:75], v[44:47]
    s_waitcnt lgkmcnt(0)
    v_mfma_f32_16x16x32_bf16 v[32:35], a[12:15], v[76:79], v[32:35]
    v_mfma_f32_16x16x32_bf16 v[36:39], a[28:31], v[76:79], v[36:39]
    v_mfma_f32_16x16x32_bf16 v[40:43], a[44:47], v[76:79], v[40:43]
    v_mfma_f32_16x16x32_bf16 v[44:47], a[60:63], v[76:79], v[44:47]
    v_mfma_f32_16x16x32_bf16 v[48:51], a[64:67], v[64:67], 0
    v_mfma_f32_16x16x32_bf16 v[52:55], a[80:83], v[64:67], 0
    v_mfma_f32_16x16x32_bf16 v[56:59], a[96:99], v[64:67], 0
    s_nop 1
    v_cvt_pk_bf16_f32 v80, v32, v33
    v_cvt_pk_bf16_f32 v81, v34, v35
    v_mfma_f32_16x16x32_bf16 v[60:63], a[112:115], v[64:67], 0
    v_cvt_pk_bf16_f32 v82, v36, v37
    v_cvt_pk_bf16_f32 v83, v38, v39
    v_mfma_f32_16x16x32_bf16 v[48:51], a[68:71], v[68:71], v[48:51]
    v_cvt_pk_bf16_f32 v84, v40, v41
    v_cvt_pk_bf16_f32 v85, v42, v43
    v_mfma_f32_16x16x32_bf16 v[52:55], a[84:87], v[68:71], v[52:55]
    v_cvt_pk_bf16_f32 v86, v44, v45
    v_cvt_pk_bf16_f32 v87, v46, v47
    v_mfma_f32_16x16x32_bf16 v[56:59], a[100:103], v[68:71], v[56:59]
    v_bfi_b32 v80, v7, s50, v80
    v_bfi_b32 v81, v7, s51, v81
    v_mfma_f32_16x16x32_bf16 v[60:63], a[116:119], v[68:71], v[60:63]
    v_bfi_b32 v82, v7, s52, v82
    v_bfi_b32 v83, v7, s53, v83
    v_mfma_f32_16x16x32_bf16 v[48:51], a[72:75], v[72:75], v[48:51]
    v_bfi_b32 v84, v7, s50, v84
    v_bfi_b32 v85, v7, s51, v85
    v_mfma_f32_16x16x32_bf16 v[52:55], a[88:91], v[72:75], v[52:55]
    v_bfi_b32 v86, v7, s52, v86
    v_bfi_b32 v87, v7, s53, v87
    v_mfma_f32_16x16x32_bf16 v[56:59], a[104:107], v[72:75], v[56:59]
    v_cndmask_b32_dpp v88, v84, v80, vcc row_ror:8 row_mask:0xf bank_mask:0xf
    v_cndmask_b32_dpp v89, v85, v81, vcc row_ror:8 row_mask:0xf bank_mask:0xf
    v_mfma_f32_16x16x32_bf16 v[60:63], a[120:123], v[72:75], v[60:63]
    v_cndmask_b32_dpp v90, v86, v82, vcc row_ror:8 row_mask:0xf bank_mask:0xf
    v_cndmask_b32_dpp v91, v87, v83, vcc row_ror:8 row_mask:0xf bank_mask:0xf
    v_mfma_f32_16x16x32_bf16 v[48:51], a[76:79], v[76:79], v[48:51]
    buffer_store_dwordx4 v[88:91], v109, s[44:47], s76 offen sc1
    s_mov_b64 vcc, s[66:67]
    v_mfma_f32_16x16x32_bf16 v[52:55], a[92:95], v[76:79], v[52:55]
    v_cndmask_b32_dpp v92, v84, v80, vcc row_ror:8 row_mask:0xf bank_mask:0xf
    v_cndmask_b32_dpp v93, v85, v81, vcc row_ror:8 row_mask:0xf bank_mask:0xf
    v_mfma_f32_16x16x32_bf16 v[56:59], a[108:111], v[76:79], v[56:59]
    v_cndmask_b32_dpp v94, v86, v82, vcc row_ror:8 row_mask:0xf bank_mask:0xf
    v_cndmask_b32_dpp v95, v87, v83, vcc row_ror:8 row_mask:0xf bank_mask:0xf
    v_mfma_f32_16x16x32_bf16 v[60:63], a[124:127], v[76:79], v[60:63]
    buffer_store_dwordx4 v[92:95], v110, s[44:47], s76 offen sc1
    s_not_b64 vcc, s[66:67]
    v_cvt_pk_bf16_f32 v80, v48, v49
    v_cvt_pk_bf16_f32 v81, v50, v51
    v_cvt_pk_bf16_f32 v82, v52, v53
    v_cvt_pk_bf16_f32 v83, v54, v55
    v_cvt_pk_bf16_f32 v84, v56, v57
    v_cvt_pk_bf16_f32 v85, v58, v59
    v_cvt_pk_bf16_f32 v86, v60, v61
    v_cvt_pk_bf16_f32 v87, v62, v63
    v_bfi_b32 v80, v7, s50, v80
    v_bfi_b32 v81, v7, s51, v81
    v_bfi_b32 v82, v7, s52, v82
    v_bfi_b32 v83, v7, s53, v83
    v_bfi_b32 v84, v7, s50, v84
    v_bfi_b32 v85, v7, s51, v85
    v_bfi_b32 v86, v7, s52, v86
    v_bfi_b32 v87, v7, s53, v87
    v_cndmask_b32_dpp v88, v84, v80, vcc row_ror:8 row_mask:0xf bank_mask:0xf
    v_cndmask_b32_dpp v89, v85, v81, vcc row_ror:8 row_mask:0xf bank_mask:0xf
    v_cndmask_b32_dpp v90, v86, v82, vcc row_ror:8 row_mask:0xf bank_mask:0xf
    v_cndmask_b32_dpp v91, v87, v83, vcc row_ror:8 row_mask:0xf bank_mask:0xf
    buffer_store_dwordx4 v[88:91], v109, s[44:47], s77 offen sc1
    s_mov_b64 vcc, s[66:67]
    v_cndmask_b32_dpp v92, v84, v80, vcc row_ror:8 row_mask:0xf bank_mask:0xf
    v_cndmask_b32_dpp v93, v85, v81, vcc row_ror:8 row_mask:0xf bank_mask:0xf
    v_cndmask_b32_dpp v94, v86, v82, vcc row_ror:8 row_mask:0xf bank_mask:0xf
    v_cndmask_b32_dpp v95, v87, v83, vcc row_ror:8 row_mask:0xf bank_mask:0xf
    buffer_store_dwordx4 v[92:95], v110, s[44:47], s77 offen sc1
    s_not_b64 vcc, s[66:67]
B_END:
    s_barrier
    s_cmp_eq_u32 s79, 1
    s_cbranch_scc1 ROLE_D
    s_cmp_eq_u32 s79, 2
    s_cbranch_scc1 ROLE_E
    s_cmp_eq_u32 s79, 3
    s_cbranch_scc1 ROLE_X
    s_cmp_ge_u32 s48, 4
    s_cbranch_scc1 C_V
    buffer_load_dwordx4 v[16:19], v100, s[44:47], s73 offen sc1
C_STATS:
    s_waitcnt vmcnt(0)
    v_xor_b32 v20, s54, v17
    v_xor_b32 v21, s54, v19
    v_or_b32 v20, v20, v21
    v_cmp_ne_u32 vcc, 0, v20
    s_nop 0
    s_cbranch_vccnz C_STATS_BAD
    v_mov_b32 v17, v18
    v_mov_b32 v20, v16
    s_nop 1
    v_max_f32_dpp v20, v20, v20 row_ror:1 row_mask:0xf bank_mask:0xf
    s_nop 1
    v_max_f32_dpp v20, v20, v20 row_ror:2 row_mask:0xf bank_mask:0xf
    s_nop 1
    v_max_f32_dpp v20, v20, v20 row_ror:4 row_mask:0xf bank_mask:0xf
    s_nop 1
    v_max_f32_dpp v20, v20, v20 row_ror:8 row_mask:0xf bank_mask:0xf
    v_mov_b32 v21, v20
    s_nop 1
    v_permlane16_swap_b32 v21, v20
    v_max_f32 v20, v20, v21
    v_sub_f32 v16, v16, v20
    v_exp_f32 v16, v16
    s_nop 0
    v_mul_f32 v20, v16, v17
    s_nop 1
    v_add_f32_dpp v20, v20, v20 row_ror:1 row_mask:0xf bank_mask:0xf
    s_nop 1
    v_add_f32_dpp v20, v20, v20 row_ror:2 row_mask:0xf bank_mask:0xf
    s_nop 1
    v_add_f32_dpp v20, v20, v20 row_ror:4 row_mask:0xf bank_mask:0xf
    s_nop 1
    v_add_f32_dpp v20, v20, v20 row_ror:8 row_mask:0xf bank_mask:0xf
    v_mov_b32 v21, v20
    s_nop 1
    v_permlane16_swap_b32 v21, v20
    v_add_f32 v20, v20, v21
    v_rcp_f32 v20, v20
    s_nop 0
    v_mul_f32 v16, v16, v20
    v_cvt_pk_bf16_f32 v16, v16, v16
    ds_write_b16 v122, v16
    s_waitcnt lgkmcnt(0)
    s_branch C_W1
C_V:
    s_waitcnt vmcnt(0)
C_W1:
    s_barrier
    s_mov_b32 m0, s75
    s_nop 0
    buffer_load_dwordx4 v101, s[44:47], s74 offen offset:0 sc1 lds
    buffer_load_dwordx4 v101, s[44:47], s74 offen offset:1024 sc1 lds
    buffer_load_dwordx4 v101, s[44:47], s74 offen offset:2048 sc1 lds
    buffer_load_dwordx4 v101, s[44:47], s74 offen offset:3072 sc1 lds
    ds_read_b64 v[24:25], v123
    ds_read_b64 v[26:27], v123 offset:32
    v_xor_b32 v8, 0, v117
    ds_read_b64_tr_b16 a[0:1], v8 offset:0
    ds_read_b64_tr_b16 a[2:3], v8 offset:2048
    ds_read_b64_tr_b16 a[4:5], v8 offset:8192
    ds_read_b64_tr_b16 a[6:7], v8 offset:10240
    v_xor_b32 v8, 0, v118
    ds_read_b64_tr_b16 a[8:9], v8 offset:0
    ds_read_b64_tr_b16 a[10:11], v8 offset:2048
    ds_read_b64_tr_b16 a[12:13], v8 offset:8192
    ds_read_b64_tr_b16 a[14:15], v8 offset:10240
    s_waitcnt lgkmcnt(6)
    v_xor_b32 v8, 32, v117
    ds_read_b64_tr_b16 a[16:17], v8 offset:0
    ds_read_b64_tr_b16 a[18:19], v8 offset:2048
    ds_read_b64_tr_b16 a[20:21], v8 offset:8192
    ds_read_b64_tr_b16 a[22:23], v8 offset:10240
    v_xor_b32 v8, 32, v118
    ds_read_b64_tr_b16 a[24:25], v8 offset:0
    ds_read_b64_tr_b16 a[26:27], v8 offset:2048
    ds_read_b64_tr_b16 a[28:29], v8 offset:8192
    ds_read_b64_tr_b16 a[30:31], v8 offset:10240
    s_waitcnt lgkmcnt(6)
    v_xor_b32 v8, 64, v117
    ds_read_b64_tr_b16 a[32:33], v8 offset:0
    ds_read_b64_tr_b16 a[34:35], v8 offset:2048
    ds_read_b64_tr_b16 a[36:37], v8 offset:8192
    ds_read_b64_tr_b16 a[38:39], v8 offset:10240
    v_xor_b32 v8, 64, v118
    ds_read_b64_tr_b16 a[40:41], v8 offset:0
    ds_read_b64_tr_b16 a[42:43], v8 offset:2048
    ds_read_b64_tr_b16 a[44:45], v8 offset:8192
    ds_read_b64_tr_b16 a[46:47], v8 offset:10240
    s_waitcnt lgkmcnt(6)
    v_xor_b32 v8, 96, v117
    ds_read_b64_tr_b16 a[48:49], v8 offset:0
    ds_read_b64_tr_b16 a[50:51], v8 offset:2048
    ds_read_b64_tr_b16 a[52:53], v8 offset:8192
    ds_read_b64_tr_b16 a[54:55], v8 offset:10240
    v_xor_b32 v8, 96, v118
    ds_read_b64_tr_b16 a[56:57], v8 offset:0
    ds_read_b64_tr_b16 a[58:59], v8 offset:2048
    ds_read_b64_tr_b16 a[60:61], v8 offset:8192
    ds_read_b64_tr_b16 a[62:63], v8 offset:10240
    s_waitcnt lgkmcnt(6)
C_HAVE:
    s_waitcnt vmcnt(0)
    ds_read_b64_tr_b16 v[32:33], v102
    ds_read_b64_tr_b16 v[34:35], v102 offset:2048
    ds_read_b64_tr_b16 v[36:37], v103
    ds_read_b64_tr_b16 v[38:39], v103 offset:2048
    ds_read_b64_tr_b16 v[40:41], v104
    ds_read_b64_tr_b16 v[42:43], v104 offset:2048
    ds_read_b64_tr_b16 v[44:45], v105
    ds_read_b64_tr_b16 v[46:47], v105 offset:2048
    v_mov_b32 v20, 0
    s_waitcnt lgkmcnt(6)
    v_mfma_f32_16x16x32_bf16 v[48:51], v[32:35], v[24:27], 0
    v_bitop3_b32 v20, v20, v32, v4 bitop3:0xf6
    v_bitop3_b32 v20, v20, v33, v4 bitop3:0xf6
    v_bitop3_b32 v20, v20, v34, v4 bitop3:0xf6
    v_bitop3_b32 v20, v20, v35, v4 bitop3:0xf6
    s_waitcnt lgkmcnt(4)
    v_mfma_f32_16x16x32_bf16 v[52:55], v[36:39], v[24:27], 0
    v_bitop3_b32 v20, v20, v36, v4 bitop3:0xf6
    v_bitop3_b32 v20, v20, v37, v4 bitop3:0xf6
    v_bitop3_b32 v20, v20, v38, v4 bitop3:0xf6
    v_bitop3_b32 v20, v20, v39, v4 bitop3:0xf6
    s_waitcnt lgkmcnt(2)
    v_mfma_f32_16x16x32_bf16 v[56:59], v[40:43], v[24:27], 0
    v_bitop3_b32 v20, v20, v40, v4 bitop3:0xf6
    v_bitop3_b32 v20, v20, v41, v4 bitop3:0xf6
    v_bitop3_b32 v20, v20, v42, v4 bitop3:0xf6
    v_bitop3_b32 v20, v20, v43, v4 bitop3:0xf6
    s_waitcnt lgkmcnt(0)
    v_mfma_f32_16x16x32_bf16 v[60:63], v[44:47], v[24:27], 0
    v_bitop3_b32 v20, v20, v44, v4 bitop3:0xf6
    v_bitop3_b32 v20, v20, v45, v4 bitop3:0xf6
    v_bitop3_b32 v20, v20, v46, v4 bitop3:0xf6
    v_bitop3_b32 v20, v20, v47, v4 bitop3:0xf6
    v_and_b32 v20, v7, v20
    v_cmp_ne_u32 vcc, 0, v20
    s_nop 0
    s_cbranch_vccnz C_PAY_BAD
    v_cvt_pk_bf16_f32 v16, v48, v49
    v_cvt_pk_bf16_f32 v17, v50, v51
    v_cvt_pk_bf16_f32 v18, v52, v53
    v_cvt_pk_bf16_f32 v19, v54, v55
    v_cvt_pk_bf16_f32 v20, v56, v57
    v_cvt_pk_bf16_f32 v21, v58, v59
    v_cvt_pk_bf16_f32 v22, v60, v61
    v_cvt_pk_bf16_f32 v23, v62, v63
    s_mov_b32 exec_lo, 0x00010001
    s_mov_b32 exec_hi, 0x00010001
    ds_write_b128 v119, v[16:19]
    ds_write_b128 v119, v[20:23] offset:16
    s_mov_b64 exec, -1
    v_mfma_f32_16x16x32_bf16 v[64:67], a[0:3], v[16:19], 0
    v_mfma_f32_16x16x32_bf16 v[68:71], a[16:19], v[16:19], 0
    v_mfma_f32_16x16x32_bf16 v[72:75], a[32:35], v[16:19], 0
    v_mfma_f32_16x16x32_bf16 v[76:79], a[48:51], v[16:19], 0
    v_mfma_f32_16x16x32_bf16 v[64:67], a[4:7], v[20:23], v[64:67]
    v_mfma_f32_16x16x32_bf16 v[68:71], a[20:23], v[20:23], v[68:71]
    v_mfma_f32_16x16x32_bf16 v[72:75], a[36:39], v[20:23], v[72:75]
    v_mfma_f32_16x16x32_bf16 v[76:79], a[52:55], v[20:23], v[76:79]
    s_waitcnt lgkmcnt(0)
    s_barrier
    ds_read_b128 v[24:27], v120
    ds_read_b128 v[28:31], v120 offset:16
    s_waitcnt lgkmcnt(1)
    v_mfma_f32_16x16x32_bf16 v[64:67], a[8:11], v[24:27], v[64:67]
    v_mfma_f32_16x16x32_bf16 v[68:71], a[24:27], v[24:27], v[68:71]
    v_mfma_f32_16x16x32_bf16 v[72:75], a[40:43], v[24:27], v[72:75]
    v_mfma_f32_16x16x32_bf16 v[76:79], a[56:59], v[24:27], v[76:79]
    s_waitcnt lgkmcnt(0)
    v_mfma_f32_16x16x32_bf16 v[64:67], a[12:15], v[28:31], v[64:67]
    v_mfma_f32_16x16x32_bf16 v[68:71], a[28:31], v[28:31], v[68:71]
    v_mfma_f32_16x16x32_bf16 v[72:75], a[44:47], v[28:31], v[72:75]
    v_mfma_f32_16x16x32_bf16 v[76:79], a[60:63], v[28:31], v[76:79]
    s_nop 4
    v_cvt_pk_bf16_f32 v32, v64, v65
    v_cvt_pk_bf16_f32 v33, v66, v67
    v_cvt_pk_bf16_f32 v34, v68, v69
    v_cvt_pk_bf16_f32 v35, v70, v71
    v_cvt_pk_bf16_f32 v36, v72, v73
    v_cvt_pk_bf16_f32 v37, v74, v75
    v_cvt_pk_bf16_f32 v38, v76, v77
    v_cvt_pk_bf16_f32 v39, v78, v79
    v_mov_b32_dpp v32, v36 quad_perm:[0,1,2,3] row_mask:0xf bank_mask:0x2
    v_mov_b32_dpp v33, v37 quad_perm:[0,1,2,3] row_mask:0xf bank_mask:0x2
    v_mov_b32_dpp v34, v38 quad_perm:[0,1,2,3] row_mask:0xf bank_mask:0x2
    v_mov_b32_dpp v35, v39 quad_perm:[0,1,2,3] row_mask:0xf bank_mask:0x2
    s_mov_b32 exec_lo, 0x00110011
    s_mov_b32 exec_hi, 0x00110011
    v_bfi_b32 v32, v7, s50, v32
    v_bfi_b32 v33, v7, s51, v33
    v_bfi_b32 v34, v7, s52, v34
    v_bfi_b32 v35, v7, s53, v35
    buffer_store_dwordx4 v[32:35], v121, s[44:47], s72 offen sc1
    s_mov_b64 exec, -1
    s_branch FIN
C_STATS_BAD:
    s_add_u32 s78, s78, 1
    s_cmp_gt_u32 s78, 0x200000
    s_cbranch_scc1 FAIL
    buffer_load_dwordx4 v[16:19], v100, s[44:47], s73 offen sc1
    s_branch C_STATS
C_PAY_BAD:
    s_add_u32 s78, s78, 1
    s_cmp_gt_u32 s78, 0x200000
    s_cbranch_scc1 FAIL
    s_mov_b32 m0, s75
    s_nop 0
    buffer_load_dwordx4 v101, s[44:47], s74 offen offset:0 sc1 lds
    buffer_load_dwordx4 v101, s[44:47], s74 offen offset:1024 sc1 lds
    buffer_load_dwordx4 v101, s[44:47], s74 offen offset:2048 sc1 lds
    buffer_load_dwordx4 v101, s[44:47], s74 offen offset:3072 sc1 lds
    s_branch C_HAVE
ROLE_X:
    s_branch FIN
ROLE_D:
    s_cmp_lt_u32 s48, 4
    s_cbranch_scc1 D_LO
    s_mov_b32 m0, s70
    s_add_u32 s70, s70, 1024
    buffer_load_dwordx4 v112, s[24:27], s69 offen nt lds
    s_add_u32 s69, s69, 8192
    s_mov_b32 m0, s70
    s_add_u32 s70, s70, 1024
    buffer_load_dwordx4 v112, s[24:27], s69 offen nt lds
    s_add_u32 s69, s69, 8192
    s_mov_b32 m0, s70
    s_add_u32 s70, s70, 1024
    buffer_load_dwordx4 v112, s[24:27], s69 offen nt lds
    s_add_u32 s69, s69, 8192
    s_mov_b32 m0, s70
    s_add_u32 s70, s70, 1024
    buffer_load_dwordx4 v112, s[24:27], s69 offen nt lds
    s_add_u32 s69, s69, 8192
    s_mov_b32 m0, s70
    s_add_u32 s70, s70, 1024
    buffer_load_dwordx4 v112, s[24:27], s69 offen nt lds
    s_add_u32 s69, s69, 8192
    s_mov_b32 m0, s70
    s_add_u32 s70, s70, 1024
    buffer_load_dwordx4 v112, s[24:27], s69 offen nt lds
    s_add_u32 s69, s69, 8192
    s_mov_b32 m0, s70
    s_add_u32 s70, s70, 1024
    buffer_load_dwordx4 v112, s[24:27], s69 offen nt lds
    s_add_u32 s69, s69, 8192
    s_mov_b32 m0, s70
    s_add_u32 s70, s70, 1024
    buffer_load_dwordx4 v112, s[24:27], s69 offen nt lds
    s_add_u32 s69, s69, 8192
    s_waitcnt vmcnt(0)
    s_barrier
    s_barrier
    s_branch FIN
D_LO:
    s_barrier
    ds_read_b64_tr_b16 a[0:1], v102 offset:0
    ds_read_b64_tr_b16 a[2:3], v102 offset:2048
    ds_read_b64_tr_b16 a[4:5], v102 offset:4096
    ds_read_b64_tr_b16 a[6:7], v102 offset:6144
    ds_read_b64_tr_b16 a[8:9], v102 offset:8192
    ds_read_b64_tr_b16 a[10:11], v102 offset:10240
    ds_read_b64_tr_b16 a[12:13], v102 offset:12288
    ds_read_b64_tr_b16 a[14:15], v102 offset:14336
    s_waitcnt lgkmcnt(6)
    ds_read_b64_tr_b16 a[16:17], v103 offset:0
    ds_read_b64_tr_b16 a[18:19], v103 offset:2048
    ds_read_b64_tr_b16 a[20:21], v103 offset:4096
    ds_read_b64_tr_b16 a[22:23], v103 offset:6144
    ds_read_b64_tr_b16 a[24:25], v103 offset:8192
    ds_read_b64_tr_b16 a[26:27], v103 offset:10240
    ds_read_b64_tr_b16 a[28:29], v103 offset:12288
    ds_read_b64_tr_b16 a[30:31], v103 offset:14336
    s_waitcnt lgkmcnt(6)
    ds_read_b64_tr_b16 a[32:33], v104 offset:0
    ds_read_b64_tr_b16 a[34:35], v104 offset:2048
    ds_read_b64_tr_b16 a[36:37], v104 offset:4096
    ds_read_b64_tr_b16 a[38:39], v104 offset:6144
    ds_read_b64_tr_b16 a[40:41], v104 offset:8192
    ds_read_b64_tr_b16 a[42:43], v104 offset:10240
    ds_read_b64_tr_b16 a[44:45], v104 offset:12288
    ds_read_b64_tr_b16 a[46:47], v104 offset:14336
    s_waitcnt lgkmcnt(6)
    ds_read_b64_tr_b16 a[48:49], v105 offset:0
    ds_read_b64_tr_b16 a[50:51], v105 offset:2048
    ds_read_b64_tr_b16 a[52:53], v105 offset:4096
    ds_read_b64_tr_b16 a[54:55], v105 offset:6144
    ds_read_b64_tr_b16 a[56:57], v105 offset:8192
    ds_read_b64_tr_b16 a[58:59], v105 offset:10240
    ds_read_b64_tr_b16 a[60:61], v105 offset:12288
    ds_read_b64_tr_b16 a[62:63], v105 offset:14336
    s_waitcnt lgkmcnt(6)
D_RETRY:
    buffer_load_dwordx4 v[64:67], v100, s[44:47], s73 offen offset:0 sc1
    buffer_load_dwordx4 v[68:71], v100, s[44:47], s73 offen offset:64 sc1
    buffer_load_dwordx4 v[72:75], v100, s[44:47], s73 offen offset:128 sc1
    buffer_load_dwordx4 v[76:79], v100, s[44:47], s73 offen offset:192 sc1
    s_add_u32 s78, s78, 1
    s_cmp_gt_u32 s78, 0x200000
    s_cbranch_scc1 FAIL
    v_mov_b32 v20, 0
    s_waitcnt vmcnt(0) lgkmcnt(0)
    v_mfma_f32_16x16x32_bf16 v[32:35], a[0:3], v[64:67], 0
    v_bitop3_b32 v20, v20, v64, s50 bitop3:0xf6
    v_mfma_f32_16x16x32_bf16 v[36:39], a[16:19], v[64:67], 0
    v_bitop3_b32 v20, v20, v65, s51 bitop3:0xf6
    v_mfma_f32_16x16x32_bf16 v[40:43], a[32:35], v[64:67], 0
    v_bitop3_b32 v20, v20, v66, s52 bitop3:0xf6
    v_mfma_f32_16x16x32_bf16 v[44:47], a[48:51], v[64:67], 0
    v_bitop3_b32 v20, v20, v67, s53 bitop3:0xf6
    v_mfma_f32_16x16x32_bf16 v[32:35], a[4:7], v[68:71], v[32:35]
    v_bitop3_b32 v20, v20, v68, s50 bitop3:0xf6
    v_mfma_f32_16x16x32_bf16 v[36:39], a[20:23], v[68:71], v[36:39]
    v_bitop3_b32 v20, v20, v69, s51 bitop3:0xf6
    v_mfma_f32_16x16x32_bf16 v[40:43], a[36:39], v[68:71], v[40:43]
    v_bitop3_b32 v20, v20, v70, s52 bitop3:0xf6
    v_mfma_f32_16x16x32_bf16 v[44:47], a[52:55], v[68:71], v[44:47]
    v_bitop3_b32 v20, v20, v71, s53 bitop3:0xf6
    v_mfma_f32_16x16x32_bf16 v[32:35], a[8:11], v[72:75], v[32:35]
    v_bitop3_b32 v20, v20, v72, s50 bitop3:0xf6
    v_mfma_f32_16x16x32_bf16 v[36:39], a[24:27], v[72:75], v[36:39]
    v_bitop3_b32 v20, v20, v73, s51 bitop3:0xf6
    v_mfma_f32_16x16x32_bf16 v[40:43], a[40:43], v[72:75], v[40:43]
    v_bitop3_b32 v20, v20, v74, s52 bitop3:0xf6
    v_mfma_f32_16x16x32_bf16 v[44:47], a[56:59], v[72:75], v[44:47]
    v_bitop3_b32 v20, v20, v75, s53 bitop3:0xf6
    v_mfma_f32_16x16x32_bf16 v[32:35], a[12:15], v[76:79], v[32:35]
    v_bitop3_b32 v20, v20, v76, s50 bitop3:0xf6
    v_mfma_f32_16x16x32_bf16 v[36:39], a[28:31], v[76:79], v[36:39]
    v_bitop3_b32 v20, v20, v77, s51 bitop3:0xf6
    v_mfma_f32_16x16x32_bf16 v[40:43], a[44:47], v[76:79], v[40:43]
    v_bitop3_b32 v20, v20, v78, s52 bitop3:0xf6
    v_mfma_f32_16x16x32_bf16 v[44:47], a[60:63], v[76:79], v[44:47]
    v_bitop3_b32 v20, v20, v79, s53 bitop3:0xf6
    v_and_b32 v20, v7, v20
    v_cmp_ne_u32 vcc, 0, v20
    s_nop 0
    s_cbranch_vccnz D_RETRY
    v_add_f32_dpp v48, v32, v32 row_ror:8 row_mask:0xf bank_mask:0x3
    v_add_f32_dpp v49, v33, v33 row_ror:8 row_mask:0xf bank_mask:0x3
    v_add_f32_dpp v50, v34, v34 row_ror:8 row_mask:0xf bank_mask:0x3
    v_add_f32_dpp v51, v35, v35 row_ror:8 row_mask:0xf bank_mask:0x3
    v_add_f32_dpp v52, v36, v36 row_ror:8 row_mask:0xf bank_mask:0x3
    v_add_f32_dpp v53, v37, v37 row_ror:8 row_mask:0xf bank_mask:0x3
    v_add_f32_dpp v54, v38, v38 row_ror:8 row_mask:0xf bank_mask:0x3
    v_add_f32_dpp v55, v39, v39 row_ror:8 row_mask:0xf bank_mask:0x3
    v_add_f32_dpp v48, v40, v40 row_ror:8 row_mask:0xf bank_mask:0xc
    v_add_f32_dpp v49, v41, v41 row_ror:8 row_mask:0xf bank_mask:0xc
    v_add_f32_dpp v50, v42, v42 row_ror:8 row_mask:0xf bank_mask:0xc
    v_add_f32_dpp v51, v43, v43 row_ror:8 row_mask:0xf bank_mask:0xc
    v_add_f32_dpp v52, v44, v44 row_ror:8 row_mask:0xf bank_mask:0xc
    v_add_f32_dpp v53, v45, v45 row_ror:8 row_mask:0xf bank_mask:0xc
    v_add_f32_dpp v54, v46, v46 row_ror:8 row_mask:0xf bank_mask:0xc
    v_add_f32_dpp v55, v47, v47 row_ror:8 row_mask:0xf bank_mask:0xc
    v_add_f32_dpp v56, v48, v48 row_ror:12 row_mask:0xf bank_mask:0x5
    v_add_f32_dpp v57, v49, v49 row_ror:12 row_mask:0xf bank_mask:0x5
    v_add_f32_dpp v58, v50, v50 row_ror:12 row_mask:0xf bank_mask:0x5
    v_add_f32_dpp v59, v51, v51 row_ror:12 row_mask:0xf bank_mask:0x5
    v_add_f32_dpp v56, v52, v52 row_ror:4 row_mask:0xf bank_mask:0xa
    v_add_f32_dpp v57, v53, v53 row_ror:4 row_mask:0xf bank_mask:0xa
    v_add_f32_dpp v58, v54, v54 row_ror:4 row_mask:0xf bank_mask:0xa
    v_add_f32_dpp v59, v55, v55 row_ror:4 row_mask:0xf bank_mask:0xa
    ds_write_b128 v114, v[56:59]
    s_waitcnt lgkmcnt(0)
    s_barrier
    s_cmp_lg_u32 s48, 0
    s_cbranch_scc1 FIN
    ds_read_b128 v[16:19], v115 offset:0
    ds_read_b128 v[20:23], v115 offset:1024
    ds_read_b128 v[24:27], v115 offset:2048
    ds_read_b128 v[28:31], v115 offset:3072
    s_waitcnt lgkmcnt(2)
    v_add_f32 v16, v16, v20
    v_add_f32 v17, v17, v21
    v_add_f32 v18, v18, v22
    v_add_f32 v19, v19, v23
    s_waitcnt lgkmcnt(0)
    v_add_f32 v24, v24, v28
    v_add_f32 v25, v25, v29
    v_add_f32 v26, v26, v30
    v_add_f32 v27, v27, v31
    v_add_f32 v16, v16, v24
    v_add_f32 v17, v17, v25
    v_add_f32 v18, v18, v26
    v_add_f32 v19, v19, v27
    v_cvt_pk_bf16_f32 v24, v16, v17
    v_cvt_pk_bf16_f32 v25, v18, v19
    v_bfi_b32 v24, v7, v5, v24
    v_bfi_b32 v25, v7, v6, v25
    buffer_store_dwordx2 v[24:25], v101, s[44:47], s75 offen sc1
    s_branch FIN
ROLE_E:
    s_cmp_lt_u32 s48, 4
    s_cbranch_scc1 E_NOLD_9
    s_mov_b32 m0, s70
    s_add_u32 s67, s70, 32768
    buffer_load_dwordx4 v112, s[28:31], s69 offen nt lds
    s_mov_b32 m0, s67
    s_add_u32 s70, s70, 1024
    buffer_load_dwordx4 v112, s[32:35], s69 offen nt lds
    s_add_u32 s69, s69, 44032
    s_mov_b32 m0, s70
    s_add_u32 s67, s70, 32768
    buffer_load_dwordx4 v112, s[28:31], s69 offen nt lds
    s_mov_b32 m0, s67
    s_add_u32 s70, s70, 1024
    buffer_load_dwordx4 v112, s[32:35], s69 offen nt lds
    s_add_u32 s69, s69, 44032
    s_mov_b32 m0, s70
    s_add_u32 s67, s70, 32768
    buffer_load_dwordx4 v112, s[28:31], s69 offen nt lds
    s_mov_b32 m0, s67
    s_add_u32 s70, s70, 1024
    buffer_load_dwordx4 v112, s[32:35], s69 offen nt lds
    s_add_u32 s69, s69, 44032
    s_mov_b32 m0, s70
    s_add_u32 s67, s70, 32768
    buffer_load_dwordx4 v112, s[28:31], s69 offen nt lds
    s_mov_b32 m0, s67
    s_add_u32 s70, s70, 1024
    buffer_load_dwordx4 v112, s[32:35], s69 offen nt lds
    s_add_u32 s69, s69, 44032
    s_mov_b32 m0, s70
    s_add_u32 s67, s70, 32768
    buffer_load_dwordx4 v112, s[28:31], s69 offen nt lds
    s_mov_b32 m0, s67
    s_add_u32 s70, s70, 1024
    buffer_load_dwordx4 v112, s[32:35], s69 offen nt lds
    s_add_u32 s69, s69, 44032
    s_mov_b32 m0, s70
    s_add_u32 s67, s70, 32768
    buffer_load_dwordx4 v112, s[28:31], s69 offen nt lds
    s_mov_b32 m0, s67
    s_add_u32 s70, s70, 1024
    buffer_load_dwordx4 v112, s[32:35], s69 offen nt lds
    s_add_u32 s69, s69, 44032
    s_sub_u32 s66, s48, 4
    s_lshl_b32 s64, s63, 5
    s_lshl_b32 s65, s66, 3
    s_add_u32 s64, s64, s65
    s_lshl_b32 s64, s64, 10
    s_mul_i32 s65, s65, 1056
    s_add_u32 s65, s65, 65536
    s_mov_b32 m0, s65
    s_add_u32 s65, s65, 1056
    buffer_load_dwordx4 v113, s[36:39], s64 offen nt lds
    s_add_u32 s64, s64, 1024
    s_mov_b32 m0, s65
    s_add_u32 s65, s65, 1056
    buffer_load_dwordx4 v113, s[36:39], s64 offen nt lds
    s_add_u32 s64, s64, 1024
    s_mov_b32 m0, s65
    s_add_u32 s65, s65, 1056
    buffer_load_dwordx4 v113, s[36:39], s64 offen nt lds
    s_add_u32 s64, s64, 1024
    s_mov_b32 m0, s65
    s_add_u32 s65, s65, 1056
    buffer_load_dwordx4 v113, s[36:39], s64 offen nt lds
    s_add_u32 s64, s64, 1024
    s_mov_b32 m0, s65
    s_add_u32 s65, s65, 1056
    buffer_load_dwordx4 v113, s[36:39], s64 offen nt lds
    s_add_u32 s64, s64, 1024
    s_mov_b32 m0, s65
    s_add_u32 s65, s65, 1056
    buffer_load_dwordx4 v113, s[36:39], s64 offen nt lds
    s_add_u32 s64, s64, 1024
    s_mov_b32 m0, s65
    s_add_u32 s65, s65, 1056
    buffer_load_dwordx4 v113, s[36:39], s64 offen nt lds
    s_add_u32 s64, s64, 1024
    s_mov_b32 m0, s65
    s_add_u32 s65, s65, 1056
    buffer_load_dwordx4 v113, s[36:39], s64 offen nt lds
    s_add_u32 s64, s64, 1024
    v_lshlrev_b32 v116, 3, v1
    v_and_b32 v8, 3, v2
    v_and_b32 v9, 1, v8
    v_lshlrev_b32 v9, 4, v9
    v_mov_b32 v10, 0x3f80
    v_lshlrev_b32 v10, v9, v10
    v_cmp_gt_u32 vcc, 2, v8
    s_nop 1
    v_cndmask_b32 v104, 0, v10, vcc
    v_cndmask_b32 v105, v10, 0, vcc
    v_mov_b32 v106, v104
    v_mov_b32 v107, v105
    v_lshrrev_b32 v8, 2, v2
    v_lshl_add_u32 v8, v3, 2, v8
    v_bfe_u32 v9, v8, 2, 1
    v_lshlrev_b32 v9, 5, v9
    v_lshl_add_u32 v9, v8, 6, v9
    v_and_b32 v8, 3, v1
    v_lshl_add_u32 v9, v8, 3, v9
    s_lshl_b32 s64, s48, 12
    s_add_u32 s64, s64, 0
    v_add_u32 v119, s64, v9
    v_xor_b32 v121, 32, v119
    v_lshrrev_b32 v9, 2, v2
    v_lshl_add_u32 v9, v3, 2, v9
    v_mul_u32_u24 v9, 1056, v9
    v_and_b32 v10, 3, v1
    v_lshl_add_u32 v9, v10, 3, v9
    s_lshl_b32 s64, s48, 7
    s_add_u32 s64, s64, 65536
    v_add_u32 v120, s64, v9
    s_lshl_b32 s73, s48, 12
    s_add_u32 s74, s73, 99328
    s_add_u32 s73, s73, 655360
    v_lshlrev_b32 v108, 4, v1
    v_add_u32 v109, s74, v116
    v_and_b32 v8, 3, v2
    v_lshlrev_b32 v8, 6, v8
    s_lshl_b32 s64, s48, 3
    s_add_u32 s64, s64, 160000
    v_add_u32 v110, s64, v8
    v_lshrrev_b32 v9, 2, v2
    v_lshl_add_u32 v8, v9, 4, v8
    v_add_u32 v111, 160000, v8
    v_and_b32 v8, 3, v2
    v_lshl_add_u32 v8, v3, 4, v8
    v_lshlrev_b32 v8, 4, v8
    s_lshr_b32 s64, s48, 2
    s_lshl_b32 s64, s64, 10
    s_and_b32 s65, s48, 3
    s_lshl_b32 s65, s65, 6
    s_add_u32 s64, s64, s65
    s_add_u32 s64, s64, 143360
    v_add_u32 v112, s64, v8
    v_lshlrev_b32 v8, 4, v1
    v_add_u32 v113, 143360, v8
    v_add_u32 v117, 135168, v8
    v_lshrrev_b32 v8, 2, v2
    v_mul_u32_u24 v8, 5504, v8
    v_and_b32 v9, 3, v2
    v_lshl_add_u32 v8, v9, 5, v8
    v_lshl_add_u32 v118, v3, 3, v8
    s_mul_i32 s75, s48, 22016
    s_lshl_b32 s64, s63, 7
    s_add_u32 s75, s75, s64
    s_add_u32 s75, s75, 720896
E_NOLD_9:
    v_and_b32 v8, 3, v2
    v_lshlrev_b32 v8, 10, v8
    v_lshl_add_u32 v8, v3, 3, v8
    s_lshl_b32 s64, s48, 7
    v_add_u32 v8, s64, v8
    buffer_load_dwordx2 v[96:97], v8, s[4:7], 0 offen offset:0
    buffer_load_dwordx2 v[98:99], v8, s[4:7], 0 offen offset:32
    buffer_load_dwordx2 v[100:101], v8, s[4:7], 0 offen offset:64
    buffer_load_dwordx2 v[102:103], v8, s[4:7], 0 offen offset:96
    s_waitcnt vmcnt(0) lgkmcnt(0)
    v_lshlrev_b32 v80, 16, v96
    v_and_b32 v81, 0xffff0000, v96
    v_lshlrev_b32 v82, 16, v97
    v_and_b32 v83, 0xffff0000, v97
    v_lshlrev_b32 v84, 16, v98
    v_and_b32 v85, 0xffff0000, v98
    v_lshlrev_b32 v86, 16, v99
    v_and_b32 v87, 0xffff0000, v99
    v_lshlrev_b32 v88, 16, v100
    v_and_b32 v89, 0xffff0000, v100
    v_lshlrev_b32 v90, 16, v101
    v_and_b32 v91, 0xffff0000, v101
    v_lshlrev_b32 v92, 16, v102
    v_and_b32 v93, 0xffff0000, v102
    v_lshlrev_b32 v94, 16, v103
    v_and_b32 v95, 0xffff0000, v103
    s_barrier
    s_mov_b32 m0, s74
    s_nop 0
    buffer_load_dwordx4 v108, s[44:47], s73 offen offset:0 sc1 lds
    buffer_load_dwordx4 v108, s[44:47], s73 offen offset:1024 sc1 lds
    buffer_load_dwordx4 v108, s[44:47], s73 offen offset:2048 sc1 lds
    buffer_load_dwordx4 v108, s[44:47], s73 offen offset:3072 sc1 lds
    ds_read_b64_tr_b16 a[0:1], v119 offset:0
    ds_read_b64_tr_b16 a[2:3], v119 offset:1024
    ds_read_b64_tr_b16 a[4:5], v119 offset:2048
    ds_read_b64_tr_b16 a[6:7], v119 offset:3072
    ds_read_b64_tr_b16 a[8:9], v121 offset:0
    ds_read_b64_tr_b16 a[10:11], v121 offset:1024
    ds_read_b64_tr_b16 a[12:13], v121 offset:2048
    ds_read_b64_tr_b16 a[14:15], v121 offset:3072
    s_waitcnt lgkmcnt(4)
    ds_read_b64_tr_b16 a[16:17], v119 offset:32768
    ds_read_b64_tr_b16 a[18:19], v119 offset:33792
    ds_read_b64_tr_b16 a[20:21], v119 offset:34816
    ds_read_b64_tr_b16 a[22:23], v119 offset:35840
    ds_read_b64_tr_b16 a[24:25], v121 offset:32768
    ds_read_b64_tr_b16 a[26:27], v121 offset:33792
    ds_read_b64_tr_b16 a[28:29], v121 offset:34816
    ds_read_b64_tr_b16 a[30:31], v121 offset:35840
    s_waitcnt lgkmcnt(4)
    ds_read_b64_tr_b16 a[32:33], v120 offset:0
    ds_read_b64_tr_b16 a[34:35], v120 offset:16896
    ds_read_b64_tr_b16 a[36:37], v120 offset:32
    ds_read_b64_tr_b16 a[38:39], v120 offset:16928
    ds_read_b64_tr_b16 a[40:41], v120 offset:64
    ds_read_b64_tr_b16 a[42:43], v120 offset:16960
    ds_read_b64_tr_b16 a[44:45], v120 offset:96
    ds_read_b64_tr_b16 a[46:47], v120 offset:16992
    s_branch E_WAIT
E_RETRY:
    s_add_u32 s78, s78, 1
    s_cmp_gt_u32 s78, 0x200000
    s_cbranch_scc1 FAIL
    s_mov_b32 m0, s74
    s_nop 0
    buffer_load_dwordx4 v108, s[44:47], s73 offen offset:0 sc1 lds
    buffer_load_dwordx4 v108, s[44:47], s73 offen offset:1024 sc1 lds
    buffer_load_dwordx4 v108, s[44:47], s73 offen offset:2048 sc1 lds
    buffer_load_dwordx4 v108, s[44:47], s73 offen offset:3072 sc1 lds
E_WAIT:
    s_waitcnt vmcnt(0) lgkmcnt(0)
    ds_read_b64_tr_b16 v[64:65], v109 offset:0
    ds_read_b64_tr_b16 v[66:67], v109 offset:512
    ds_read_b64_tr_b16 v[68:69], v109 offset:1024
    ds_read_b64_tr_b16 v[70:71], v109 offset:1536
    ds_read_b64_tr_b16 v[72:73], v109 offset:2048
    ds_read_b64_tr_b16 v[74:75], v109 offset:2560
    ds_read_b64_tr_b16 v[76:77], v109 offset:3072
    ds_read_b64_tr_b16 v[78:79], v109 offset:3584
    v_mov_b32 v20, 0
    s_waitcnt lgkmcnt(6)
    v_mfma_f32_16x16x32_bf16 v[32:35], v[64:67], v[104:107], v[80:83]
    v_bitop3_b32 v20, v20, v64, v4 bitop3:0xf6
    v_bitop3_b32 v20, v20, v65, v4 bitop3:0xf6
    v_bitop3_b32 v20, v20, v66, v4 bitop3:0xf6
    v_bitop3_b32 v20, v20, v67, v4 bitop3:0xf6
    s_waitcnt lgkmcnt(4)
    v_mfma_f32_16x16x32_bf16 v[36:39], v[68:71], v[104:107], v[84:87]
    v_bitop3_b32 v20, v20, v68, v4 bitop3:0xf6
    v_bitop3_b32 v20, v20, v69, v4 bitop3:0xf6
    v_bitop3_b32 v20, v20, v70, v4 bitop3:0xf6
    v_bitop3_b32 v20, v20, v71, v4 bitop3:0xf6
    s_waitcnt lgkmcnt(2)
    v_mfma_f32_16x16x32_bf16 v[40:43], v[72:75], v[104:107], v[88:91]
    v_bitop3_b32 v20, v20, v72, v4 bitop3:0xf6
    v_bitop3_b32 v20, v20, v73, v4 bitop3:0xf6
    v_bitop3_b32 v20, v20, v74, v4 bitop3:0xf6
    v_bitop3_b32 v20, v20, v75, v4 bitop3:0xf6
    s_waitcnt lgkmcnt(0)
    v_mfma_f32_16x16x32_bf16 v[44:47], v[76:79], v[104:107], v[92:95]
    v_bitop3_b32 v20, v20, v76, v4 bitop3:0xf6
    v_bitop3_b32 v20, v20, v77, v4 bitop3:0xf6
    v_bitop3_b32 v20, v20, v78, v4 bitop3:0xf6
    v_bitop3_b32 v20, v20, v79, v4 bitop3:0xf6
    v_and_b32 v20, v7, v20
    v_cmp_ne_u32 vcc, 0, v20
    s_nop 0
    s_cbranch_vccnz E_RETRY
    v_pk_add_f32 v[16:17], v[32:33], v[34:35]
    v_pk_mul_f32 v[18:19], v[32:33], v[32:33]
    v_pk_fma_f32 v[18:19], v[34:35], v[34:35], v[18:19]
    v_pk_add_f32 v[16:17], v[16:17], v[36:37]
    v_pk_fma_f32 v[18:19], v[36:37], v[36:37], v[18:19]
    v_pk_add_f32 v[16:17], v[16:17], v[38:39]
    v_pk_fma_f32 v[18:19], v[38:39], v[38:39], v[18:19]
    v_pk_add_f32 v[16:17], v[16:17], v[40:41]
    v_pk_fma_f32 v[18:19], v[40:41], v[40:41], v[18:19]
    v_pk_add_f32 v[16:17], v[16:17], v[42:43]
    v_pk_fma_f32 v[18:19], v[42:43], v[42:43], v[18:19]
    v_pk_add_f32 v[16:17], v[16:17], v[44:45]
    v_pk_fma_f32 v[18:19], v[44:45], v[44:45], v[18:19]
    v_pk_add_f32 v[16:17], v[16:17], v[46:47]
    v_pk_fma_f32 v[18:19], v[46:47], v[46:47], v[18:19]
    v_add_f32 v16, v16, v17
    v_add_f32 v17, v18, v19
    v_mov_b32 v18, v16
    v_mov_b32 v19, v17
    s_nop 0
    v_permlane16_swap_b32 v18, v16
    v_permlane16_swap_b32 v19, v17
    v_add_f32 v16, v16, v18
    v_add_f32 v17, v17, v19
    v_mov_b32 v18, v16
    v_mov_b32 v19, v17
    s_nop 0
    v_permlane32_swap_b32 v18, v16
    v_permlane32_swap_b32 v19, v17
    v_add_f32 v16, v16, v18
    v_add_f32 v17, v17, v19
    s_mov_b64 exec, 0xf
    ds_write_b64 v110, v[16:17]
    s_mov_b64 exec, -1
    s_waitcnt lgkmcnt(0)
    s_barrier
    ds_read_b128 v[16:19], v111
    s_waitcnt lgkmcnt(0)
    v_add_f32 v16, v16, v18
    v_add_f32 v17, v17, v19
    s_nop 0
    v_add_f32_dpp v16, v16, v16 row_ror:8 row_mask:0xf bank_mask:0xf
    v_add_f32_dpp v17, v17, v17 row_ror:8 row_mask:0xf bank_mask:0xf
    s_nop 0
    v_add_f32_dpp v16, v16, v16 row_ror:4 row_mask:0xf bank_mask:0xf
    v_add_f32_dpp v17, v17, v17 row_ror:4 row_mask:0xf bank_mask:0xf
    v_mul_f32 v16, 0x3b000000, v16
    v_mul_f32 v17, 0x3b000000, v17
    v_fma_f32 v17, -v16, v16, v17
    v_add_f32 v17, 0x3727c5ac, v17
    v_rsq_f32 v17, v17
    s_nop 0
    v_mul_f32 v16, v16, v17
    v_pk_fma_f32 v[64:65], v[32:33], v[16:17], v[16:17] op_sel:[0,1,0] op_sel_hi:[1,1,0] neg_lo:[0,0,1] neg_hi:[0,0,1]
    v_pk_fma_f32 v[66:67], v[34:35], v[16:17], v[16:17] op_sel:[0,1,0] op_sel_hi:[1,1,0] neg_lo:[0,0,1] neg_hi:[0,0,1]
    v_pk_fma_f32 v[68:69], v[36:37], v[16:17], v[16:17] op_sel:[0,1,0] op_sel_hi:[1,1,0] neg_lo:[0,0,1] neg_hi:[0,0,1]
    v_pk_fma_f32 v[70:71], v[38:39], v[16:17], v[16:17] op_sel:[0,1,0] op_sel_hi:[1,1,0] neg_lo:[0,0,1] neg_hi:[0,0,1]
    v_pk_fma_f32 v[72:73], v[40:41], v[16:17], v[16:17] op_sel:[0,1,0] op_sel_hi:[1,1,0] neg_lo:[0,0,1] neg_hi:[0,0,1]
    v_pk_fma_f32 v[74:75], v[42:43], v[16:17], v[16:17] op_sel:[0,1,0] op_sel_hi:[1,1,0] neg_lo:[0,0,1] neg_hi:[0,0,1]
    v_pk_fma_f32 v[76:77], v[44:45], v[16:17], v[16:17] op_sel:[0,1,0] op_sel_hi:[1,1,0] neg_lo:[0,0,1] neg_hi:[0,0,1]
    v_pk_fma_f32 v[78:79], v[46:47], v[16:17], v[16:17] op_sel:[0,1,0] op_sel_hi:[1,1,0] neg_lo:[0,0,1] neg_hi:[0,0,1]
    v_cvt_pk_bf16_f32 v48, v64, v65
    v_cvt_pk_bf16_f32 v49, v66, v67
    v_cvt_pk_bf16_f32 v50, v68, v69
    v_cvt_pk_bf16_f32 v51, v70, v71
    v_cvt_pk_bf16_f32 v52, v72, v73
    v_cvt_pk_bf16_f32 v53, v74, v75
    v_cvt_pk_bf16_f32 v54, v76, v77
    v_cvt_pk_bf16_f32 v55, v78, v79
    v_mfma_f32_16x16x32_bf16 v[56:59], a[0:3], v[48:51], 0
    v_mfma_f32_16x16x32_bf16 v[60:63], a[8:11], v[48:51], 0
    v_mfma_f32_16x16x32_bf16 v[64:67], a[16:19], v[48:51], 0
    v_mfma_f32_16x16x32_bf16 v[68:71], a[24:27], v[48:51], 0
    v_mfma_f32_16x16x32_bf16 v[56:59], a[4:7], v[52:55], v[56:59]
    v_mfma_f32_16x16x32_bf16 v[60:63], a[12:15], v[52:55], v[60:63]
    v_mfma_f32_16x16x32_bf16 v[64:67], a[20:23], v[52:55], v[64:67]
    v_mfma_f32_16x16x32_bf16 v[68:71], a[28:31], v[52:55], v[68:71]
    s_lshr_b32 s64, s63, 2
    s_cmp_lg_u32 s64, s48
    s_cbranch_scc1 E_NOH_10
    ds_write_b128 v117, v[32:35] offset:0
    ds_write_b128 v117, v[36:39] offset:1024
    ds_write_b128 v117, v[40:43] offset:2048
    ds_write_b128 v117, v[44:47] offset:3072
E_NOH_10:
    s_mov_b32 exec_lo, 0x000f000f
    s_mov_b32 exec_hi, 0x000f000f
    ds_write_b128 v112, v[56:59] offset:0
    ds_write_b128 v112, v[60:63] offset:2048
    ds_write_b128 v112, v[64:67] offset:4096
    ds_write_b128 v112, v[68:71] offset:6144
    s_mov_b64 exec, -1
    s_waitcnt lgkmcnt(0)
    s_barrier
    ds_read_b128 v[64:67], v113 offset:0
    ds_read_b128 v[80:83], v113 offset:1024
    ds_read_b128 v[68:71], v113 offset:2048
    ds_read_b128 v[84:87], v113 offset:3072
    ds_read_b128 v[72:75], v113 offset:4096
    ds_read_b128 v[88:91], v113 offset:5120
    ds_read_b128 v[76:79], v113 offset:6144
    ds_read_b128 v[92:95], v113 offset:7168
    s_waitcnt lgkmcnt(6)
    v_pk_add_f32 v[64:65], v[64:65], v[80:81]
    v_pk_add_f32 v[66:67], v[66:67], v[82:83]
    s_waitcnt lgkmcnt(4)
    v_pk_add_f32 v[68:69], v[68:69], v[84:85]
    v_pk_add_f32 v[70:71], v[70:71], v[86:87]
    s_waitcnt lgkmcnt(2)
    v_pk_add_f32 v[72:73], v[72:73], v[88:89]
    v_pk_add_f32 v[74:75], v[74:75], v[90:91]
    s_waitcnt lgkmcnt(0)
    v_pk_add_f32 v[76:77], v[76:77], v[92:93]
    v_pk_add_f32 v[78:79], v[78:79], v[94:95]
    v_add_f32_dpp v64, v64, v64 row_ror:8 row_mask:0xf bank_mask:0xf
    v_add_f32_dpp v65, v65, v65 row_ror:8 row_mask:0xf bank_mask:0xf
    v_add_f32_dpp v66, v66, v66 row_ror:8 row_mask:0xf bank_mask:0xf
    v_add_f32_dpp v67, v67, v67 row_ror:8 row_mask:0xf bank_mask:0xf
    v_add_f32_dpp v68, v68, v68 row_ror:8 row_mask:0xf bank_mask:0xf
    v_add_f32_dpp v69, v69, v69 row_ror:8 row_mask:0xf bank_mask:0xf
    v_add_f32_dpp v70, v70, v70 row_ror:8 row_mask:0xf bank_mask:0xf
    v_add_f32_dpp v71, v71, v71 row_ror:8 row_mask:0xf bank_mask:0xf
    v_add_f32_dpp v72, v72, v72 row_ror:8 row_mask:0xf bank_mask:0xf
    v_add_f32_dpp v73, v73, v73 row_ror:8 row_mask:0xf bank_mask:0xf
    v_add_f32_dpp v74, v74, v74 row_ror:8 row_mask:0xf bank_mask:0xf
    v_add_f32_dpp v75, v75, v75 row_ror:8 row_mask:0xf bank_mask:0xf
    v_add_f32_dpp v76, v76, v76 row_ror:8 row_mask:0xf bank_mask:0xf
    v_add_f32_dpp v77, v77, v77 row_ror:8 row_mask:0xf bank_mask:0xf
    v_add_f32_dpp v78, v78, v78 row_ror:8 row_mask:0xf bank_mask:0xf
    v_add_f32_dpp v79, v79, v79 row_ror:8 row_mask:0xf bank_mask:0xf
    v_add_f32_dpp v64, v64, v64 row_ror:4 row_mask:0xf bank_mask:0xf
    v_add_f32_dpp v65, v65, v65 row_ror:4 row_mask:0xf bank_mask:0xf
    v_add_f32_dpp v66, v66, v66 row_ror:4 row_mask:0xf bank_mask:0xf
    v_add_f32_dpp v67, v67, v67 row_ror:4 row_mask:0xf bank_mask:0xf
    v_add_f32_dpp v68, v68, v68 row_ror:4 row_mask:0xf bank_mask:0xf
    v_add_f32_dpp v69, v69, v69 row_ror:4 row_mask:0xf bank_mask:0xf
    v_add_f32_dpp v70, v70, v70 row_ror:4 row_mask:0xf bank_mask:0xf
    v_add_f32_dpp v71, v71, v71 row_ror:4 row_mask:0xf bank_mask:0xf
    v_add_f32_dpp v72, v72, v72 row_ror:4 row_mask:0xf bank_mask:0xf
    v_add_f32_dpp v73, v73, v73 row_ror:4 row_mask:0xf bank_mask:0xf
    v_add_f32_dpp v74, v74, v74 row_ror:4 row_mask:0xf bank_mask:0xf
    v_add_f32_dpp v75, v75, v75 row_ror:4 row_mask:0xf bank_mask:0xf
    v_add_f32_dpp v76, v76, v76 row_ror:4 row_mask:0xf bank_mask:0xf
    v_add_f32_dpp v77, v77, v77 row_ror:4 row_mask:0xf bank_mask:0xf
    v_add_f32_dpp v78, v78, v78 row_ror:4 row_mask:0xf bank_mask:0xf
    v_add_f32_dpp v79, v79, v79 row_ror:4 row_mask:0xf bank_mask:0xf
    v_max_f32 v64, 0, v64
    v_max_f32 v65, 0, v65
    v_max_f32 v66, 0, v66
    v_max_f32 v67, 0, v67
    v_max_f32 v68, 0, v68
    v_max_f32 v69, 0, v69
    v_max_f32 v70, 0, v70
    v_max_f32 v71, 0, v71
    v_pk_mul_f32 v[64:65], v[64:65], v[72:73]
    v_pk_mul_f32 v[66:67], v[66:67], v[74:75]
    v_pk_mul_f32 v[68:69], v[68:69], v[76:77]
    v_pk_mul_f32 v[70:71], v[70:71], v[78:79]
    v_cvt_pk_bf16_f32 v16, v64, v65
    v_cvt_pk_bf16_f32 v17, v66, v67
    v_cvt_pk_bf16_f32 v18, v68, v69
    v_cvt_pk_bf16_f32 v19, v70, v71
    s_nop 1
    v_mfma_f32_16x16x32_bf16 v[32:35], a[32:35], v[16:19], 0
    v_mfma_f32_16x16x32_bf16 v[36:39], a[36:39], v[16:19], 0
    v_mfma_f32_16x16x32_bf16 v[40:43], a[40:43], v[16:19], 0
    v_mfma_f32_16x16x32_bf16 v[44:47], a[44:47], v[16:19], 0
    s_nop 4
    v_cvt_pk_bf16_f32 v48, v32, v33
    v_cvt_pk_bf16_f32 v49, v34, v35
    v_cvt_pk_bf16_f32 v50, v36, v37
    v_cvt_pk_bf16_f32 v51, v38, v39
    v_cvt_pk_bf16_f32 v52, v40, v41
    v_cvt_pk_bf16_f32 v53, v42, v43
    v_cvt_pk_bf16_f32 v54, v44, v45
    v_cvt_pk_bf16_f32 v55, v46, v47
    v_mov_b32_dpp v48, v50 quad_perm:[0,1,2,3] row_mask:0xf bank_mask:0x2
    v_mov_b32_dpp v49, v51 quad_perm:[0,1,2,3] row_mask:0xf bank_mask:0x2
    s_nop 0
    v_mov_b32_dpp v48, v52 quad_perm:[0,1,2,3] row_mask:0xf bank_mask:0x4
    v_mov_b32_dpp v49, v53 quad_perm:[0,1,2,3] row_mask:0xf bank_mask:0x4
    s_nop 0
    v_mov_b32_dpp v48, v54 quad_perm:[0,1,2,3] row_mask:0xf bank_mask:0x8
    v_mov_b32_dpp v49, v55 quad_perm:[0,1,2,3] row_mask:0xf bank_mask:0x8
    v_bfi_b32 v48, v7, v5, v48
    v_bfi_b32 v49, v7, v6, v49
    buffer_store_dwordx2 v[48:49], v118, s[44:47], s75 offen sc1
    s_cmp_ge_u32 s63, 32
    s_cbranch_scc1 FIN
    s_lshl_b32 s64, s48, 3
    v_lshrrev_b32 v8, 3, v1
    v_add_u32 v8, s64, v8
    v_min_u32 v8, 42, v8
    v_and_b32 v9, 7, v1
    v_lshlrev_b32 v9, 4, v9
    v_lshl_add_u32 v96, v8, 7, v9
    s_mul_i32 s73, s63, 5504
    s_add_u32 s73, s73, 720896
    s_lshl_b32 s74, s48, 10
    s_add_u32 s74, s74, 0
    v_add_u32 v98, s74, v116
    s_cmp_eq_u32 s48, 5
    s_cselect_b32 s64, 3, 4
    s_cselect_b32 s65, 0, 4
    v_cmp_gt_u32 vcc, s64, v3
    s_nop 1
    v_cndmask_b32 v100, 0, v104, vcc
    v_cndmask_b32 v101, 0, v105, vcc
    v_cmp_gt_u32 vcc, s65, v3
    s_nop 1
    v_cndmask_b32 v102, 0, v104, vcc
    v_cndmask_b32 v103, 0, v105, vcc
    v_and_b32 v8, 3, v2
    v_lshl_add_u32 v9, v3, 4, v8
    v_lshlrev_b32 v9, 4, v9
    s_lshr_b32 s64, s48, 2
    s_lshl_b32 s64, s64, 10
    s_and_b32 s65, s48, 3
    s_lshl_b32 s65, s65, 6
    s_add_u32 s64, s64, s65
    s_add_u32 s64, s64, 155904
    v_add_u32 v114, s64, v9
    v_lshlrev_b32 v10, 4, v1
    v_add_u32 v115, 155904, v10
    s_and_b32 s64, s63, 3
    s_lshl_b32 s64, s64, 10
    s_add_u32 s64, s64, 135168
    v_add_u32 v99, s64, v9
    v_lshlrev_b32 v9, 10, v8
    v_lshl_add_u32 v9, v3, 3, v9
    s_lshl_b32 s64, s63, 5
    v_add_u32 v108, s64, v9
    v_mov_b32 v16, 0
    v_mov_b32 v17, 0
    v_mov_b32 v18, 0
    v_mov_b32 v19, 0
    s_waitcnt vmcnt(0)
    s_barrier
    s_cmp_ge_u32 s48, 6
    s_cbranch_scc1 F_RED
F_RETRY:
    s_mov_b32 m0, s74
    s_add_u32 s78, s78, 1
    s_cmp_gt_u32 s78, 0x200000
    s_cbranch_scc1 FAIL
    buffer_load_dwordx4 v96, s[44:47], s73 offen sc1 lds
    v_mov_b32 v20, 0
    s_waitcnt vmcnt(0)
    ds_read_b64_tr_b16 v[64:65], v98
    ds_read_b64_tr_b16 v[66:67], v98 offset:512
    s_waitcnt lgkmcnt(0)
    v_mfma_f32_16x16x32_bf16 v[16:19], v[64:67], v[100:103], 0
    v_bitop3_b32 v20, v20, v64, v4 bitop3:0xf6
    v_bitop3_b32 v20, v20, v65, v4 bitop3:0xf6
    v_bitop3_b32 v20, v20, v66, v4 bitop3:0xf6
    v_bitop3_b32 v20, v20, v67, v4 bitop3:0xf6
    v_and_b32 v20, v7, v20
    v_cmp_ne_u32 vcc, 0, v20
    s_nop 0
    s_cbranch_vccnz F_RETRY
F_RED:
    s_nop 7
    s_mov_b32 exec_lo, 0x000f000f
    s_mov_b32 exec_hi, 0x000f000f
    ds_write_b128 v114, v[16:19]
    s_mov_b64 exec, -1
    s_waitcnt lgkmcnt(0)
    s_barrier
    s_cmp_lg_u32 s48, 0
    s_cbranch_scc1 FIN
    ds_read_b128 v[24:27], v99
    ds_read_b128 v[16:19], v115
    ds_read_b128 v[20:23], v115 offset:1024
    s_waitcnt lgkmcnt(0)
    v_add_f32 v16, v16, v20
    v_add_f32 v17, v17, v21
    v_add_f32 v18, v18, v22
    v_add_f32 v19, v19, v23
    v_add_f32_dpp v16, v16, v16 row_ror:8 row_mask:0xf bank_mask:0xf
    v_add_f32_dpp v17, v17, v17 row_ror:8 row_mask:0xf bank_mask:0xf
    v_add_f32_dpp v18, v18, v18 row_ror:8 row_mask:0xf bank_mask:0xf
    v_add_f32_dpp v19, v19, v19 row_ror:8 row_mask:0xf bank_mask:0xf
    v_add_f32_dpp v16, v16, v16 row_ror:4 row_mask:0xf bank_mask:0xf
    v_add_f32_dpp v17, v17, v17 row_ror:4 row_mask:0xf bank_mask:0xf
    v_add_f32_dpp v18, v18, v18 row_ror:4 row_mask:0xf bank_mask:0xf
    v_add_f32_dpp v19, v19, v19 row_ror:4 row_mask:0xf bank_mask:0xf
    v_add_f32 v16, v16, v24
    v_add_f32 v17, v17, v25
    v_add_f32 v18, v18, v26
    v_add_f32 v19, v19, v27
    v_cvt_pk_bf16_f32 v24, v16, v17
    v_cvt_pk_bf16_f32 v25, v18, v19
    s_mov_b32 exec_lo, 0x000f000f
    s_mov_b32 exec_hi, 0x000f000f
    buffer_store_dwordx2 v[24:25], v108, s[40:43], 0 offen
    s_mov_b64 exec, -1
    s_cmp_lg_u32 s63, 0
    s_cbranch_scc1 F3_11
    s_add_u32 s64, s49, 1
    v_mov_b32 v8, s64
    v_mov_b32 v9, 0
    s_mov_b64 exec, 1
    buffer_store_dword v8, v9, s[44:47], 0 offen sc1
    s_mov_b64 exec, -1
F3_11:
    s_branch FIN
Q_RETRY:
    s_add_u32 s78, s78, 1
    s_cmp_gt_u32 s78, 0x200000
    s_cbranch_scc1 FAIL
    s_add_u32 s64, s68, 0
    s_mov_b32 m0, s64
    s_add_u32 s65, s67, 0
    buffer_load_dwordx4 v14, s[44:47], s65 offen sc1 lds
    s_add_u32 s64, s68, 1024
    s_mov_b32 m0, s64
    s_add_u32 s65, s67, 0
    buffer_load_dwordx4 v15, s[44:47], s65 offen sc1 lds
    s_add_u32 s64, s68, 2048
    s_mov_b32 m0, s64
    s_add_u32 s65, s67, 128
    buffer_load_dwordx4 v14, s[44:47], s65 offen sc1 lds
    s_add_u32 s64, s68, 3072
    s_mov_b32 m0, s64
    s_add_u32 s65, s67, 128
    buffer_load_dwordx4 v15, s[44:47], s65 offen sc1 lds
    s_branch Q_CHECK
LOADER:
    s_lshr_b32 s60, s65, 1
    s_lshl_b32 s60, s60, 3
    s_add_u32 s60, s60, s64
    s_mov_b32 s10, 0x1000000
    s_mov_b32 s11, 0x20000
    s_sub_u32 s66, s48, 4
    s_lshl_b32 s66, s66, 5
    s_mul_i32 s67, s66, 1056
    s_lshl_b32 s68, s66, 10
    s_lshl_b32 s66, s60, 17
    s_add_u32 s68, s68, s66
    v_lshlrev_b32 v8, 4, v1
    s_waitcnt lgkmcnt(0)
    s_load_dword s49, s[44:45], 0
    s_barrier
    s_mov_b32 m0, s67
    s_add_u32 s67, s67, 1056
    buffer_load_dwordx4 v8, s[8:11], s68 offen nt lds
    s_add_u32 s68, s68, 1024
    s_mov_b32 m0, s67
    s_add_u32 s67, s67, 1056
    buffer_load_dwordx4 v8, s[8:11], s68 offen nt lds
    s_add_u32 s68, s68, 1024
    s_mov_b32 m0, s67
    s_add_u32 s67, s67, 1056
    buffer_load_dwordx4 v8, s[8:11], s68 offen nt lds
    s_add_u32 s68, s68, 1024
    s_mov_b32 m0, s67
    s_add_u32 s67, s67, 1056
    buffer_load_dwordx4 v8, s[8:11], s68 offen nt lds
    s_add_u32 s68, s68, 1024
    s_mov_b32 m0, s67
    s_add_u32 s67, s67, 1056
    buffer_load_dwordx4 v8, s[8:11], s68 offen nt lds
    s_add_u32 s68, s68, 1024
    s_mov_b32 m0, s67
    s_add_u32 s67, s67, 1056
    buffer_load_dwordx4 v8, s[8:11], s68 offen nt lds
    s_add_u32 s68, s68, 1024
    s_and_b32 s64, s2, 7
    s_lshr_b32 s65, s2, 3
    s_and_b32 s55, s65, 3
    s_lshl_b32 s55, s55, 3
    s_add_u32 s55, s55, s64
    s_lshr_b32 s56, s65, 2
    s_and_b32 s58, s65, 1
    s_lshr_b32 s57, s60, 5
    s_and_b32 s59, s60, 31
    s_load_dwordx2 s[16:17], s[0:1], 24
    s_load_dwordx2 s[20:21], s[0:1], 32
    s_load_dwordx2 s[24:25], s[0:1], 40
    s_load_dwordx2 s[28:29], s[0:1], 56
    s_load_dwordx2 s[32:33], s[0:1], 64
    s_load_dwordx2 s[36:37], s[0:1], 72
    s_load_dwordx2 s[40:41], s[0:1], 80
    s_sub_u32 s61, s65, 16
    s_mov_b32 s62, s64
    s_mul_i32 s63, s64, 6
    s_add_u32 s63, s63, s65
    s_sub_u32 s63, s63, 24
    s_mov_b32 s79, 3
    s_cmp_lt_u32 s63, 43
    s_cselect_b32 s79, 2, s79
    s_cmp_ge_u32 s65, 30
    s_cselect_b32 s79, 3, s79
    s_cmp_lt_u32 s65, 24
    s_cselect_b32 s79, 1, s79
    s_cmp_lt_u32 s65, 16
    s_cselect_b32 s79, 0, s79
    s_mov_b32 s6, 0x1000
    s_mov_b32 s7, 0x20000
    s_mov_b32 s14, 0x400000
    s_mov_b32 s15, 0x20000
    s_mov_b32 s46, 0x10000000
    s_mov_b32 s47, 0x20000
    s_mov_b32 s18, 0x400000
    s_mov_b32 s19, 0x20000
    s_mov_b32 s22, 0x400000
    s_mov_b32 s23, 0x20000
    s_mov_b32 s26, 0x400000
    s_mov_b32 s27, 0x20000
    s_mov_b32 s30, 0x158000
    s_mov_b32 s31, 0x20000
    s_mov_b32 s34, 0x158000
    s_mov_b32 s35, 0x20000
    s_mov_b32 s38, 0x158000
    s_mov_b32 s39, 0x20000
    s_mov_b32 s42, 0x1000
    s_mov_b32 s43, 0x20000
    s_mov_b32 s78, 0
    v_mov_b32 v7, 0x10001
    v_mov_b32 v14, 0
    v_mov_b32 v15, 0
    v_mov_b32 v96, 0
    v_mov_b32 v97, 0
    v_mov_b32 v98, 0
    v_mov_b32 v99, 0
    v_mov_b32 v100, 0
    v_mov_b32 v101, 0
    v_mov_b32 v102, 0
    v_mov_b32 v103, 0
    v_mov_b32 v104, 0
    v_mov_b32 v105, 0
    v_mov_b32 v106, 0
    v_mov_b32 v107, 0
    v_mov_b32 v108, 0
    v_mov_b32 v109, 0
    v_mov_b32 v110, 0
    v_mov_b32 v111, 0
    v_mov_b32 v112, 0
    v_mov_b32 v113, 0
    v_mov_b32 v114, 0
    v_mov_b32 v115, 0
    v_mov_b32 v116, 0
    v_mov_b32 v117, 0
    v_mov_b32 v118, 0
    v_mov_b32 v119, 0
    v_mov_b32 v120, 0
    v_mov_b32 v121, 0
    v_mov_b32 v122, 0
    v_mov_b32 v123, 0
    s_mov_b32 m0, s67
    s_add_u32 s67, s67, 1056
    buffer_load_dwordx4 v8, s[8:11], s68 offen nt lds
    s_add_u32 s68, s68, 1024
    s_waitcnt vmcnt(6)
    s_mov_b32 m0, s67
    s_add_u32 s67, s67, 1056
    buffer_load_dwordx4 v8, s[8:11], s68 offen nt lds
    s_add_u32 s68, s68, 1024
    s_waitcnt vmcnt(6)
    s_mov_b32 m0, s67
    s_add_u32 s67, s67, 1056
    buffer_load_dwordx4 v8, s[8:11], s68 offen nt lds
    s_add_u32 s68, s68, 1024
    s_waitcnt vmcnt(6)
    s_mov_b32 m0, s67
    s_add_u32 s67, s67, 1056
    buffer_load_dwordx4 v8, s[8:11], s68 offen nt lds
    s_add_u32 s68, s68, 1024
    s_waitcnt vmcnt(6)
    s_mov_b32 m0, s67
    s_add_u32 s67, s67, 1056
    buffer_load_dwordx4 v8, s[8:11], s68 offen nt lds
    s_add_u32 s68, s68, 1024
    s_waitcnt vmcnt(6)
    s_mov_b32 m0, s67
    s_add_u32 s67, s67, 1056
    buffer_load_dwordx4 v8, s[8:11], s68 offen nt lds
    s_add_u32 s68, s68, 1024
    s_waitcnt vmcnt(6)
    s_mov_b32 m0, s67
    s_add_u32 s67, s67, 1056
    buffer_load_dwordx4 v8, s[8:11], s68 offen nt lds
    s_add_u32 s68, s68, 1024
    s_waitcnt vmcnt(6)
    s_mov_b32 m0, s67
    s_add_u32 s67, s67, 1056
    buffer_load_dwordx4 v8, s[8:11], s68 offen nt lds
    s_add_u32 s68, s68, 1024
    s_waitcnt vmcnt(6)
    s_mov_b32 m0, s67
    s_add_u32 s67, s67, 1056
    buffer_load_dwordx4 v8, s[8:11], s68 offen nt lds
    s_add_u32 s68, s68, 1024
    s_waitcnt vmcnt(6)
    s_mov_b32 m0, s67
    s_add_u32 s67, s67, 1056
    buffer_load_dwordx4 v8, s[8:11], s68 offen nt lds
    s_add_u32 s68, s68, 1024
    s_waitcnt vmcnt(6)
    s_mov_b32 m0, s67
    s_add_u32 s67, s67, 1056
    buffer_load_dwordx4 v8, s[8:11], s68 offen nt lds
    s_add_u32 s68, s68, 1024
    s_waitcnt vmcnt(6)
    s_mov_b32 m0, s67
    s_add_u32 s67, s67, 1056
    buffer_load_dwordx4 v8, s[8:11], s68 offen nt lds
    s_add_u32 s68, s68, 1024
    s_waitcnt vmcnt(6)
    s_mov_b32 m0, s67
    s_add_u32 s67, s67, 1056
    buffer_load_dwordx4 v8, s[8:11], s68 offen nt lds
    s_add_u32 s68, s68, 1024
    s_waitcnt vmcnt(6)
    s_mov_b32 m0, s67
    s_add_u32 s67, s67, 1056
    buffer_load_dwordx4 v8, s[8:11], s68 offen nt lds
    s_add_u32 s68, s68, 1024
    s_waitcnt vmcnt(6)
    s_mov_b32 m0, s67
    s_add_u32 s67, s67, 1056
    buffer_load_dwordx4 v8, s[8:11], s68 offen nt lds
    s_add_u32 s68, s68, 1024
    s_waitcnt vmcnt(6)
    s_mov_b32 m0, s67
    s_add_u32 s67, s67, 1056
    buffer_load_dwordx4 v8, s[8:11], s68 offen nt lds
    s_add_u32 s68, s68, 1024
    s_waitcnt vmcnt(6)
    s_mov_b32 m0, s67
    s_add_u32 s67, s67, 1056
    buffer_load_dwordx4 v8, s[8:11], s68 offen nt lds
    s_add_u32 s68, s68, 1024
    s_waitcnt vmcnt(6)
    s_mov_b32 m0, s67
    s_add_u32 s67, s67, 1056
    buffer_load_dwordx4 v8, s[8:11], s68 offen nt lds
    s_add_u32 s68, s68, 1024
    s_waitcnt vmcnt(6)
    s_mov_b32 m0, s67
    s_add_u32 s67, s67, 1056
    buffer_load_dwordx4 v8, s[8:11], s68 offen nt lds
    s_add_u32 s68, s68, 1024
    s_waitcnt vmcnt(6)
    s_mov_b32 m0, s67
    s_add_u32 s67, s67, 1056
    buffer_load_dwordx4 v8, s[8:11], s68 offen nt lds
    s_add_u32 s68, s68, 1024
    s_waitcnt vmcnt(6)
    s_mov_b32 m0, s67
    s_add_u32 s67, s67, 1056
    buffer_load_dwordx4 v8, s[8:11], s68 offen nt lds
    s_add_u32 s68, s68, 1024
    s_waitcnt vmcnt(6)
    s_mov_b32 m0, s67
    s_add_u32 s67, s67, 1056
    buffer_load_dwordx4 v8, s[8:11], s68 offen nt lds
    s_add_u32 s68, s68, 1024
    s_waitcnt vmcnt(6)
    s_mov_b32 m0, s67
    s_add_u32 s67, s67, 1056
    buffer_load_dwordx4 v8, s[8:11], s68 offen nt lds
    s_add_u32 s68, s68, 1024
    s_waitcnt vmcnt(6)
    s_mov_b32 m0, s67
    s_add_u32 s67, s67, 1056
    buffer_load_dwordx4 v8, s[8:11], s68 offen nt lds
    s_add_u32 s68, s68, 1024
    s_waitcnt vmcnt(6)
    s_mov_b32 m0, s67
    s_add_u32 s67, s67, 1056
    buffer_load_dwordx4 v8, s[8:11], s68 offen nt lds
    s_add_u32 s68, s68, 1024
    s_waitcnt vmcnt(6)
    s_mov_b32 m0, s67
    s_add_u32 s67, s67, 1056
    buffer_load_dwordx4 v8, s[8:11], s68 offen nt lds
    s_add_u32 s68, s68, 1024
    s_waitcnt lgkmcnt(0)
    s_and_b32 s50, s49, 1
    s_bfe_u32 s64, s49, 0x10001
    s_lshl_b32 s64, s64, 16
    s_or_b32 s50, s50, s64
    s_bfe_u32 s51, s49, 0x10002
    s_bfe_u32 s64, s49, 0x10003
    s_lshl_b32 s64, s64, 16
    s_or_b32 s51, s51, s64
    s_xor_b32 s52, s50, 0x10001
    s_xor_b32 s53, s51, 0x10001
    s_mul_i32 s54, s49, 0x9e3779b1
    s_add_u32 s54, s54, 0x7f4a7c15
    v_and_b32 v8, 1, v3
    v_cmp_ne_u32 vcc, 0, v8
    v_mov_b32 v9, s50
    v_mov_b32 v10, s52
    v_cndmask_b32 v5, v9, v10, vcc
    v_mov_b32 v11, s51
    v_mov_b32 v12, s53
    v_cndmask_b32 v6, v11, v12, vcc
    v_and_b32 v8, 2, v1
    v_cmp_ne_u32 vcc, 0, v8
    s_nop 1
    v_cndmask_b32 v13, v9, v11, vcc
    v_cndmask_b32 v14, v10, v12, vcc
    v_and_b32 v8, 4, v1
    v_cmp_ne_u32 vcc, 0, v8
    s_nop 1
    v_cndmask_b32 v13, v13, v14, vcc
    v_and_b32 v8, 1, v1
    v_lshlrev_b32 v8, 4, v8
    v_lshrrev_b32 v13, v8, v13
    v_and_b32 v13, 1, v13
    v_mul_u32_u24 v4, v7, v13
    v_lshrrev_b32 v8, 2, v2
    v_lshl_add_u32 v8, v3, 2, v8
    v_mul_u32_u24 v8, 1056, v8
    v_and_b32 v9, 3, v1
    v_lshl_add_u32 v8, v9, 3, v8
    s_sub_u32 s65, s48, 4
    s_lshl_b32 s64, s65, 8
    v_add_u32 v97, s64, v8
    v_add_u32 v98, 67584, v97
    v_lshlrev_b32 v8, 4, v1
    v_add_u32 v106, 155904, v8
    v_and_b32 v8, 7, v2
    v_mul_u32_u24 v8, 134144, v8
    v_lshrrev_b32 v9, 3, v2
    v_lshl_add_u32 v10, v3, 4, v8
    v_lshl_add_u32 v109, v9, 6, v10
    v_xor_b32 v9, 1, v9
    v_lshl_add_u32 v110, v9, 6, v10
    v_add_u32 v110, 1073152, v110
    s_mul_i32 s76, s58, 2146304
    s_mul_i32 s64, s65, 33536
    s_add_u32 s76, s76, s64
    s_lshl_b32 s64, s57, 12
    s_add_u32 s76, s76, s64
    s_lshl_b32 s64, s59, 7
    s_add_u32 s76, s76, s64
    s_add_u32 s76, s76, 2097152
    s_add_u32 s77, s76, 16768
    s_cmp_eq_u32 s79, 1
    s_cbranch_scc1 RA_12
    s_cmp_eq_u32 s79, 2
    s_cbranch_scc1 RA_13
    v_lshrrev_b32 v9, 1, v2
    v_xor_b32 v8, v3, v9
    v_lshlrev_b32 v8, 5, v8
    v_lshl_add_u32 v8, v3, 13, v8
    v_and_b32 v9, 1, v1
    v_lshl_add_u32 v112, v9, 4, v8
    v_xor_b32 v113, 128, v112
    s_sub_u32 s65, s48, 4
    s_lshl_b32 s69, s56, 7
    s_lshl_b32 s64, s65, 5
    s_add_u32 s69, s69, s64
    s_lshl_b32 s69, s69, 13
    s_lshl_b32 s64, s55, 8
    s_add_u32 s69, s69, s64
    s_lshl_b32 s70, s65, 13
    s_add_u32 s70, s70, 0
    s_branch RA_14
RA_12:
    v_lshrrev_b32 v8, 3, v1
    v_lshlrev_b32 v8, 10, v8
    v_bfe_u32 v9, v1, 1, 2
    v_xor_b32 v9, v9, v3
    v_lshl_add_u32 v8, v9, 5, v8
    v_and_b32 v9, 1, v1
    v_lshl_add_u32 v112, v9, 4, v8
    s_sub_u32 s66, s48, 4
    s_lshl_b32 s69, s66, 3
    s_add_u32 s69, s69, s62
    s_lshl_b32 s69, s69, 17
    s_lshl_b32 s65, s61, 7
    s_add_u32 s69, s69, s65
    s_lshl_b32 s70, s66, 14
    s_add_u32 s70, s70, 0
    s_branch RA_14
RA_13:
    v_lshrrev_b32 v8, 2, v1
    v_mul_u32_u24 v10, 2752, v8
    v_bfe_u32 v8, v8, 2, 1
    v_bfe_u32 v9, v1, 1, 1
    v_xor_b32 v8, v8, v9
    v_lshl_add_u32 v10, v8, 5, v10
    v_and_b32 v9, 1, v1
    v_lshl_add_u32 v112, v9, 4, v10
    v_lshlrev_b32 v113, 4, v1
    s_sub_u32 s66, s48, 4
    s_mul_i32 s69, s66, 352256
    s_lshl_b32 s65, s63, 6
    s_add_u32 s69, s69, s65
    s_lshl_b32 s70, s66, 13
    s_add_u32 s70, s70, 0
RA_14:
    s_waitcnt vmcnt(0)
    s_branch JOIN_X1
FIN:
END:
    s_endpgm
FAIL:
    s_load_dwordx2 s[64:65], s[0:1], 88
    s_waitcnt lgkmcnt(0)
    s_mov_b32 s66, 256
    s_mov_b32 s67, 0x20000
    v_mov_b32 v8, 0
    v_mov_b32 v9, 0xdead
    buffer_store_dword v9, v8, s[64:67], 0 offen
    s_waitcnt vmcnt(0)
    s_endpgm
.section .rodata,"a"
.p2align 6
.amdhsa_kernel sequential_preLN__compressed_kv_cla__glu_gated_reglu__decode_kernel
  .amdhsa_next_free_vgpr 256
  .amdhsa_next_free_sgpr 102
  .amdhsa_accum_offset 128
  .amdhsa_group_segment_fixed_size 0
  .amdhsa_kernarg_size 104
  .amdhsa_user_sgpr_count 2
  .amdhsa_user_sgpr_kernarg_segment_ptr 1
  .amdhsa_system_sgpr_workgroup_id_x 1
.end_amdhsa_kernel
```
